```python
import torch

def _softmax(x, axis=-1):
    return torch.softmax(x, dim=axis)
def _gelu(x):
    return torch.nn.functional.gelu(x, approximate="tanh")
def _silu(x):
    return torch.nn.functional.silu(x)
def _sigmoid(x):
    return torch.sigmoid(x)
def _layernorm(x, axis=-1, eps=1e-5):
    m = x.mean(dim=axis, keepdim=True)
    v = x.var(dim=axis, keepdim=True, unbiased=False)
    return (x - m) / torch.sqrt(v + eps)
def _scatter_add(tgt, idx, src, axis=0):
    return tgt.clone().index_add_(axis, idx, src)
def _segment_sum(src, seg, n):
    out = torch.zeros((n,) + src.shape[1:], dtype=src.dtype)
    return out.index_add_(0, seg, src)
def _pad(x, pw):
    flat = tuple(v for pair in reversed(pw) for v in pair)
    return torch.nn.functional.pad(x, flat)

kernel_name = 'standalone__seq2seq_rnn_t_joint__speech'

def setup_inputs():

    _w = (lambda a: (lambda t: t.to(torch.bfloat16) if t.is_floating_point() else t)(torch.as_tensor(a)))
    B, T, D, K = 2, 4000, 144, 15
    U = 8
    sc = (1.0 / (K * D)) ** 0.5
    sd = (1.0 / D) ** 0.5
    return {
        "x": _w((lambda *s: torch.randn(*s, dtype=torch.bfloat16) * 0.2)(B, T, D) * 0.5),
        "w1": _w((lambda *s: torch.randn(*s, dtype=torch.bfloat16) * 3.2)(K, D, D) * sc),
        "w2": _w((lambda *s: torch.randn(*s, dtype=torch.bfloat16) * 3.2)(K, D, D) * sc),
        "g": _w((lambda *s: torch.randn(*s, dtype=torch.bfloat16) * 3.2)(B, U, D) * 0.5),
        "w_f": _w((lambda *s: torch.randn(*s, dtype=torch.bfloat16) * 3.2)(D, D) * sd),
        "w_g": _w((lambda *s: torch.randn(*s, dtype=torch.bfloat16) * 3.2)(D, D) * sd),
        "w_o": _w((lambda *s: torch.randn(*s, dtype=torch.bfloat16) * 3.2)(D, D) * sd),
    }

def reference(x, w1, w2, g, w_f, w_g, w_o):
    B, T, D = x.shape
    K = w1.shape[0]
    pad = K // 2
    xp = _pad(x, ((0,0),(pad,pad),(0,0)))
    h = torch.zeros_like(x)
    for i in range(K):
        h = h + torch.einsum("btc,cd->btd", xp[:, i:i+T, :], w1[i])
    h = _gelu(h)[:, ::2, :]
    T1 = h.shape[1]
    hp = _pad(h, ((0,0),(pad,pad),(0,0)))
    f = torch.zeros_like(h)
    for i in range(K):
        f = f + torch.einsum("btc,cd->btd", hp[:, i:i+T1, :], w2[i])
    f = _gelu(f)[:, ::2, :]
    fe = torch.einsum("btd,de->bte", f, w_f)
    ge = torch.einsum("bud,de->bue", g, w_g)
    j = torch.tanh(fe[:, :, None, :] + ge[:, None, :, :])
    return torch.einsum("btud,dv->btuv", j, w_o)
```

```asm
; @launch grid=(256,1,1) block=(256,1,1) lds=163840
.amdgcn_target "amdgcn-amd-amdhsa--gfx950"
.text
.globl standalone__seq2seq_rnn_t_joint__speech_kernel
.p2align 8
.type standalone__seq2seq_rnn_t_joint__speech_kernel,@function
standalone__seq2seq_rnn_t_joint__speech_kernel:
    s_load_dwordx4 s[20:23], s[0:1], 0
    s_load_dwordx4 s[52:55], s[0:1], 64
    s_load_dwordx2 s[24:25], s[0:1], 16
    s_load_dwordx2 s[44:45], s[0:1], 32
    s_load_dwordx4 s[48:51], s[0:1], 48
    s_cmp_ge_u32 s2, 256
    s_cbranch_scc1 K1_END

    s_and_b32 s34, s2, 7
    s_lshr_b32 s35, s2, 3
    s_cmp_ge_u32 s35, 27
    s_cbranch_scc1 K1_TAILMAP
    s_mul_i32 s36, s35, 57
    s_lshr_b32 s36, s36, 9
    s_mul_i32 s28, s34, 3
    s_add_u32 s28, s28, s36
    s_mul_i32 s36, s36, 9
    s_sub_u32 s29, s35, s36
    s_branch K1_MAPPED
K1_TAILMAP:
    s_and_b32 s36, s34, 1
    s_mul_i32 s36, s36, 5
    s_add_u32 s36, s36, s35
    s_sub_u32 s29, s36, 27
    s_lshr_b32 s28, s34, 1
    s_cmp_lt_u32 s29, 9
    s_cbranch_scc1 K1_TAILOK
    s_cmp_eq_u32 s28, 0
    s_cbranch_scc1 K1_AUX
    s_branch K1_END
K1_TAILOK:
    s_add_u32 s28, s28, 24
K1_MAPPED:
    s_cmp_ge_u32 s28, 14
    s_cselect_b32 s30, 1, 0
    s_mul_i32 s36, s30, 14
    s_sub_u32 s31, s28, s36
    s_mul_i32 s33, s31, 72
    v_lshrrev_b32 v6, 6, v0
    v_and_b32 v1, 63, v0
    v_readfirstlane_b32 s32, v6

    v_and_b32 v2, 15, v1
    v_lshrrev_b32 v3, 4, v1
    v_lshrrev_b32 v4, 2, v2
    v_and_b32 v5, 3, v1
    s_lshl_b32 s34, s28, 7
    s_add_u32 s34, s34, 5259264
    s_lshl_b32 s35, s29, 2
    s_add_u32 s35, s35, s34
    v_min_u32 v6, 8, v1
    v_lshl_add_u32 v251, v6, 2, s34
    v_cmp_eq_u32 vcc, 0, v0
    v_mov_b32 v6, 0x80000000
    v_mov_b32 v7, s35
    s_lshl_b32 s34, s28, 3
    v_mov_b32 v8, s34
    v_cndmask_b32 v248, v6, v7, vcc
    v_cndmask_b32 v249, v6, v8, vcc
    v_mov_b32 v253, 0
    v_lshlrev_b32 v254, 4, v0
    s_lshl_b32 s38, s32, 10
    s_mul_i32 s36, s30, 1152000
    s_waitcnt lgkmcnt(0)
    s_add_u32 s4, s20, s36
    s_addc_u32 s5, s21, 0
    s_and_b32 s5, s5, 0xffff
    s_mov_b32 s6, 1152000
    s_mov_b32 s7, 0x20000

    s_mov_b32 s16, s54
    s_and_b32 s17, s55, 0xffff
    s_mov_b32 s18, 5262848
    s_mov_b32 s19, 0x20000
    s_lshl_b32 s36, s33, 1
    s_sub_u32 s36, s36, 12
    s_mul_i32 s36, s36, 576

    buffer_store_dword v253, v248, s[16:19], 0 offen sc1
    v_add_u32 v6, 0, v0
    v_mul_u32_u24 v7, 113360, v6
    v_lshrrev_b32 v7, 22, v7
    v_sub_u32 v6, v6, v7
    s_add_u32 m0, s38, 0
    v_lshl_add_u32 v6, v6, 4, s36
    buffer_load_dwordx4 v6, s[4:7], 0 offen lds
    v_add_u32 v8, 256, v0
    v_mul_u32_u24 v9, 113360, v8
    v_lshrrev_b32 v9, 22, v9
    v_sub_u32 v8, v8, v9
    s_add_u32 m0, s38, 4096
    v_lshl_add_u32 v8, v8, 4, s36
    buffer_load_dwordx4 v8, s[4:7], 0 offen lds
    v_add_u32 v6, 512, v0
    v_mul_u32_u24 v7, 113360, v6
    v_lshrrev_b32 v7, 22, v7
    v_sub_u32 v6, v6, v7
    s_add_u32 m0, s38, 8192
    v_lshl_add_u32 v6, v6, 4, s36
    buffer_load_dwordx4 v6, s[4:7], 0 offen lds
    v_add_u32 v8, 768, v0
    v_mul_u32_u24 v9, 113360, v8
    v_lshrrev_b32 v9, 22, v9
    v_sub_u32 v8, v8, v9
    s_add_u32 m0, s38, 12288
    v_lshl_add_u32 v8, v8, 4, s36
    buffer_load_dwordx4 v8, s[4:7], 0 offen lds
    v_add_u32 v6, 1024, v0
    v_mul_u32_u24 v7, 113360, v6
    v_lshrrev_b32 v7, 22, v7
    v_sub_u32 v6, v6, v7
    s_add_u32 m0, s38, 16384
    v_lshl_add_u32 v6, v6, 4, s36
    buffer_load_dwordx4 v6, s[4:7], 0 offen lds
    v_add_u32 v8, 1280, v0
    v_mul_u32_u24 v9, 113360, v8
    v_lshrrev_b32 v9, 22, v9
    v_sub_u32 v8, v8, v9
    s_add_u32 m0, s38, 20480
    v_lshl_add_u32 v8, v8, 4, s36
    buffer_load_dwordx4 v8, s[4:7], 0 offen lds
    v_add_u32 v6, 1536, v0
    v_mul_u32_u24 v7, 113360, v6
    v_lshrrev_b32 v7, 22, v7
    v_sub_u32 v6, v6, v7
    s_add_u32 m0, s38, 24576
    v_lshl_add_u32 v6, v6, 4, s36
    buffer_load_dwordx4 v6, s[4:7], 0 offen lds
    v_add_u32 v8, 1792, v0
    v_mul_u32_u24 v9, 113360, v8
    v_lshrrev_b32 v9, 22, v9
    v_sub_u32 v8, v8, v9
    s_add_u32 m0, s38, 28672
    v_lshl_add_u32 v8, v8, 4, s36
    buffer_load_dwordx4 v8, s[4:7], 0 offen lds
    v_add_u32 v6, 2048, v0
    v_mul_u32_u24 v7, 113360, v6
    v_lshrrev_b32 v7, 22, v7
    v_sub_u32 v6, v6, v7
    s_add_u32 m0, s38, 32768
    v_lshl_add_u32 v6, v6, 4, s36
    buffer_load_dwordx4 v6, s[4:7], 0 offen lds
    v_add_u32 v8, 2304, v0
    v_mul_u32_u24 v9, 113360, v8
    v_lshrrev_b32 v9, 22, v9
    v_sub_u32 v8, v8, v9
    s_add_u32 m0, s38, 36864
    v_lshl_add_u32 v8, v8, 4, s36
    buffer_load_dwordx4 v8, s[4:7], 0 offen lds
    v_add_u32 v6, 2560, v0
    v_mul_u32_u24 v7, 113360, v6
    v_lshrrev_b32 v7, 22, v7
    v_sub_u32 v6, v6, v7
    s_add_u32 m0, s38, 40960
    v_lshl_add_u32 v6, v6, 4, s36
    buffer_load_dwordx4 v6, s[4:7], 0 offen lds
    v_add_u32 v8, 2816, v0
    v_mul_u32_u24 v9, 113360, v8
    v_lshrrev_b32 v9, 22, v9
    v_sub_u32 v8, v8, v9
    s_add_u32 m0, s38, 45056
    v_lshl_add_u32 v8, v8, 4, s36
    buffer_load_dwordx4 v8, s[4:7], 0 offen lds
    v_add_u32 v6, 3072, v0
    v_mul_u32_u24 v7, 113360, v6
    v_lshrrev_b32 v7, 22, v7
    v_sub_u32 v6, v6, v7
    s_add_u32 m0, s38, 49152
    v_lshl_add_u32 v6, v6, 4, s36
    buffer_load_dwordx4 v6, s[4:7], 0 offen lds
    v_add_u32 v8, 3328, v0
    v_mul_u32_u24 v9, 113360, v8
    v_lshrrev_b32 v9, 22, v9
    v_sub_u32 v8, v8, v9
    s_add_u32 m0, s38, 53248
    v_lshl_add_u32 v8, v8, 4, s36
    buffer_load_dwordx4 v8, s[4:7], 0 offen lds
    v_add_u32 v6, 3584, v0
    v_mul_u32_u24 v7, 113360, v6
    v_lshrrev_b32 v7, 22, v7
    v_sub_u32 v6, v6, v7
    s_add_u32 m0, s38, 57344
    v_lshl_add_u32 v6, v6, 4, s36
    buffer_load_dwordx4 v6, s[4:7], 0 offen lds
    v_add_u32 v8, 3840, v0
    v_mul_u32_u24 v9, 113360, v8
    v_lshrrev_b32 v9, 22, v9
    v_sub_u32 v8, v8, v9
    s_add_u32 m0, s38, 61440
    v_lshl_add_u32 v8, v8, 4, s36
    buffer_load_dwordx4 v8, s[4:7], 0 offen lds
    v_add_u32 v6, 4096, v0
    v_mul_u32_u24 v7, 113360, v6
    v_lshrrev_b32 v7, 22, v7
    v_sub_u32 v6, v6, v7
    s_add_u32 m0, s38, 65536
    v_lshl_add_u32 v6, v6, 4, s36
    buffer_load_dwordx4 v6, s[4:7], 0 offen lds
    v_add_u32 v8, 4352, v0
    v_mul_u32_u24 v9, 113360, v8
    v_lshrrev_b32 v9, 22, v9
    v_sub_u32 v8, v8, v9
    s_add_u32 m0, s38, 69632
    v_lshl_add_u32 v8, v8, 4, s36
    buffer_load_dwordx4 v8, s[4:7], 0 offen lds
    v_add_u32 v6, 4608, v0
    v_mul_u32_u24 v7, 113360, v6
    v_lshrrev_b32 v7, 22, v7
    v_sub_u32 v6, v6, v7
    s_add_u32 m0, s38, 73728
    v_lshl_add_u32 v6, v6, 4, s36
    buffer_load_dwordx4 v6, s[4:7], 0 offen lds
    v_add_u32 v8, 4864, v0
    v_mul_u32_u24 v9, 113360, v8
    v_lshrrev_b32 v9, 22, v9
    v_sub_u32 v8, v8, v9
    s_add_u32 m0, s38, 77824
    v_lshl_add_u32 v8, v8, 4, s36
    buffer_load_dwordx4 v8, s[4:7], 0 offen lds
    v_add_u32 v6, 5120, v0
    v_mul_u32_u24 v7, 113360, v6
    v_lshrrev_b32 v7, 22, v7
    v_sub_u32 v6, v6, v7
    s_add_u32 m0, s38, 81920
    v_lshl_add_u32 v6, v6, 4, s36
    buffer_load_dwordx4 v6, s[4:7], 0 offen lds
    v_add_u32 v8, 5376, v0
    v_mul_u32_u24 v9, 113360, v8
    v_lshrrev_b32 v9, 22, v9
    v_sub_u32 v8, v8, v9
    s_add_u32 m0, s38, 86016
    v_lshl_add_u32 v8, v8, 4, s36
    buffer_load_dwordx4 v8, s[4:7], 0 offen lds
    v_add_u32 v6, 5632, v0
    v_mul_u32_u24 v7, 113360, v6
    v_lshrrev_b32 v7, 22, v7
    v_sub_u32 v6, v6, v7
    s_add_u32 m0, s38, 90112
    v_lshl_add_u32 v6, v6, 4, s36
    buffer_load_dwordx4 v6, s[4:7], 0 offen lds
    v_add_u32 v8, 5888, v0
    v_mul_u32_u24 v9, 113360, v8
    v_lshrrev_b32 v9, 22, v9
    v_sub_u32 v8, v8, v9
    s_add_u32 m0, s38, 94208
    v_lshl_add_u32 v8, v8, 4, s36
    buffer_load_dwordx4 v8, s[4:7], 0 offen lds
    v_add_u32 v6, 6144, v0
    v_mul_u32_u24 v7, 113360, v6
    v_lshrrev_b32 v7, 22, v7
    v_sub_u32 v6, v6, v7
    s_add_u32 m0, s38, 98304
    v_lshl_add_u32 v6, v6, 4, s36
    buffer_load_dwordx4 v6, s[4:7], 0 offen lds
    s_mov_b32 s8, s22
    s_and_b32 s9, s23, 0xffff
    s_mov_b32 s10, 622080
    s_mov_b32 s11, 0x20000
    s_mov_b32 s12, s24
    s_and_b32 s13, s25, 0xffff
    s_mov_b32 s14, 622080
    s_mov_b32 s15, 0x20000
    s_mov_b32 s40, s52
    s_and_b32 s41, s53, 0xffff
    s_mov_b32 s42, 256
    s_mov_b32 s43, 0x20000
    s_mov_b32 s80, s44
    s_and_b32 s81, s45, 0xffff
    s_mov_b32 s82, 41472
    s_mov_b32 s83, 0x20000
    s_mov_b32 s84, s48
    s_and_b32 s85, s49, 0xffff
    s_mov_b32 s86, 41472
    s_mov_b32 s87, 0x20000
    s_mov_b32 s88, s50
    s_and_b32 s89, s51, 0xffff
    s_mov_b32 s90, 4608000
    s_mov_b32 s91, 0x20000
    s_mov_b32 s92, 36864
    s_mov_b32 s93, -128
    v_lshrrev_b32 v7, 1, v1
    v_and_b32 v6, 0x13, v7
    v_and_b32 v8, 4, v7
    v_lshlrev_b32 v8, 1, v8
    v_or_b32 v6, v6, v8
    v_and_b32 v8, 8, v7
    v_lshrrev_b32 v8, 1, v8
    v_or_b32 v6, v6, v8
    v_and_b32 v8, 1, v1
    v_lshlrev_b32 v8, 4, v8
    s_lshl_b32 s36, s29, 5
    v_add_u32 v8, s36, v8
    s_lshl_b32 s34, s32, 6
    v_add_u32 v9, s34, v6
    v_mul_u32_u24 v12, 288, v9
    v_add_u32 v12, v12, v8
    v_subrev_u32 v10, 41472, v12
    v_subrev_u32 v11, 32256, v12
    v_add_u32 v12, 41472, v12
    s_mul_i32 s34, s32, 576
    s_add_u32 s34, s34, 112
    v_add_u32 v9, s34, v6
    v_mul_u32_u24 v13, 288, v9
    v_add_u32 v13, v13, v8
    s_mul_i32 s37, s32, 10240
    s_add_u32 s37, s37, 102400

    s_add_u32 m0, s37, 0
    s_nop 0
    buffer_load_dwordx4 v10, s[8:11], 0 offen lds
    s_add_u32 m0, s37, 1024
    s_mov_b32 s34, 0
    buffer_load_dwordx4 v12, s[8:11], s34 offen lds
    s_add_u32 m0, s37, 2048
    s_mov_b32 s34, 82944
    buffer_load_dwordx4 v12, s[8:11], s34 offen lds
    s_add_u32 m0, s37, 3072
    s_mov_b32 s34, 165888
    buffer_load_dwordx4 v12, s[8:11], s34 offen lds
    s_add_u32 m0, s37, 4096
    s_mov_b32 s34, 248832
    buffer_load_dwordx4 v12, s[8:11], s34 offen lds
    s_add_u32 m0, s37, 5120
    s_mov_b32 s34, 331776
    buffer_load_dwordx4 v12, s[8:11], s34 offen lds
    s_add_u32 m0, s37, 6144
    s_mov_b32 s34, 414720
    buffer_load_dwordx4 v12, s[8:11], s34 offen lds
    s_add_u32 m0, s37, 7168
    s_mov_b32 s34, 497664
    buffer_load_dwordx4 v12, s[8:11], s34 offen lds
    s_add_u32 m0, s37, 8192
    s_nop 0
    buffer_load_dwordx4 v11, s[8:11], 0 offen lds
    s_add_u32 m0, s37, 9216
    s_mov_b32 s34, 9216
    buffer_load_dwordx4 v12, s[8:11], s34 offen lds
    v_mul_u32_u24 v14, 5920, v2
    v_lshl_add_u32 v14, v3, 4, v14
    s_mul_i32 s34, s32, 1184
    s_add_u32 s34, s34, 512
    v_add_u32 v15, s34, v14
    s_lshl_b32 s34, s32, 7
    v_add_u32 v14, s34, v14
    v_lshrrev_b32 v6, 1, v3
    v_lshlrev_b32 v6, 4, v6
    v_and_b32 v7, 1, v3
    v_lshl_add_u32 v6, v7, 2, v6
    v_add_u32 v6, v6, v4
    v_lshlrev_b32 v6, 5, v6
    v_lshl_add_u32 v6, v5, 3, v6
    v_add_u32 v9, s37, v6
    v_mov_b32 v253, 1
    s_mul_i32 s35, s29, 4608

    s_waitcnt vmcnt(10)
    s_barrier
    ds_read_b128 v[56:59], v14 offset:0
    ds_read_b128 v[60:63], v14 offset:592
    ds_read_b128 v[64:67], v14 offset:1184
    ds_read_b128 v[68:71], v14 offset:1776
    ds_read_b128 v[72:75], v14 offset:2368
    ds_read_b128 v[76:79], v14 offset:2960
    ds_read_b128 v[80:83], v14 offset:3552
    ds_read_b128 v[84:87], v14 offset:4144
    ds_read_b128 v[88:91], v14 offset:4736
    ds_read_b128 v[92:95], v14 offset:5328
    buffer_atomic_add v253, v249, s[40:43], 0 offen sc1
    s_waitcnt vmcnt(10)
    ds_read_b64_tr_b16 v[192:193], v9 offset:0
    ds_read_b64_tr_b16 v[194:195], v9 offset:256
    ds_read_b128 v[96:99], v14 offset:5920
    ds_read_b128 v[100:103], v14 offset:6512
    ds_read_b128 v[104:107], v14 offset:7104
    ds_read_b128 v[108:111], v14 offset:7696
    ds_read_b128 v[112:115], v14 offset:8288
    ds_read_b128 v[116:119], v14 offset:8880
    ds_read_b128 v[120:123], v14 offset:9472
    s_waitcnt lgkmcnt(7)
    s_add_u32 m0, s37, 0
    s_mov_b32 s34, 92160
    buffer_load_dwordx4 v12, s[8:11], s34 offen lds
    s_waitcnt vmcnt(10)
    ds_read_b64_tr_b16 v[196:197], v9 offset:1024
    ds_read_b64_tr_b16 v[198:199], v9 offset:1280
    ds_read_b128 v[124:127], v14 offset:64
    ds_read_b128 v[128:131], v14 offset:656
    ds_read_b128 v[132:135], v14 offset:1248
    v_mfma_f32_16x16x32_bf16 v[16:19], v[192:195], v[56:59], 0
    v_mfma_f32_16x16x32_bf16 v[20:23], v[192:195], v[60:63], 0
    v_mfma_f32_16x16x32_bf16 v[24:27], v[192:195], v[64:67], 0
    v_mfma_f32_16x16x32_bf16 v[28:31], v[192:195], v[68:71], 0
    v_mfma_f32_16x16x32_bf16 v[32:35], v[192:195], v[72:75], 0
    v_mfma_f32_16x16x32_bf16 v[36:39], v[192:195], v[76:79], 0
    v_mfma_f32_16x16x32_bf16 v[40:43], v[192:195], v[80:83], 0
    v_mfma_f32_16x16x32_bf16 v[44:47], v[192:195], v[84:87], 0
    v_mfma_f32_16x16x32_bf16 v[48:51], v[192:195], v[88:91], 0
    v_mfma_f32_16x16x32_bf16 v[52:55], v[192:195], v[92:95], 0
    s_waitcnt lgkmcnt(0)
    s_add_u32 m0, s37, 1024
    s_mov_b32 s34, 175104
    buffer_load_dwordx4 v12, s[8:11], s34 offen lds
    s_waitcnt vmcnt(10)
    ds_read_b64_tr_b16 v[192:193], v9 offset:2048
    ds_read_b64_tr_b16 v[194:195], v9 offset:2304
    ds_read_b128 v[136:139], v14 offset:1840
    ds_read_b128 v[140:143], v14 offset:2432
    v_mfma_f32_16x16x32_bf16 v[16:19], v[196:199], v[60:63], v[16:19]
    v_mfma_f32_16x16x32_bf16 v[20:23], v[196:199], v[64:67], v[20:23]
    v_mfma_f32_16x16x32_bf16 v[24:27], v[196:199], v[68:71], v[24:27]
    v_mfma_f32_16x16x32_bf16 v[28:31], v[196:199], v[72:75], v[28:31]
    v_mfma_f32_16x16x32_bf16 v[32:35], v[196:199], v[76:79], v[32:35]
    v_mfma_f32_16x16x32_bf16 v[36:39], v[196:199], v[80:83], v[36:39]
    v_mfma_f32_16x16x32_bf16 v[40:43], v[196:199], v[84:87], v[40:43]
    v_mfma_f32_16x16x32_bf16 v[44:47], v[196:199], v[88:91], v[44:47]
    v_mfma_f32_16x16x32_bf16 v[48:51], v[196:199], v[92:95], v[48:51]
    v_mfma_f32_16x16x32_bf16 v[52:55], v[196:199], v[96:99], v[52:55]
    s_waitcnt lgkmcnt(0)
    s_add_u32 m0, s37, 2048
    s_mov_b32 s34, 258048
    buffer_load_dwordx4 v12, s[8:11], s34 offen lds
    s_waitcnt vmcnt(10)
    ds_read_b64_tr_b16 v[196:197], v9 offset:3072
    ds_read_b64_tr_b16 v[198:199], v9 offset:3328
    ds_read_b128 v[144:147], v14 offset:3024
    ds_read_b128 v[148:151], v14 offset:3616
    v_mfma_f32_16x16x32_bf16 v[16:19], v[192:195], v[64:67], v[16:19]
    v_mfma_f32_16x16x32_bf16 v[20:23], v[192:195], v[68:71], v[20:23]
    v_mfma_f32_16x16x32_bf16 v[24:27], v[192:195], v[72:75], v[24:27]
    v_mfma_f32_16x16x32_bf16 v[28:31], v[192:195], v[76:79], v[28:31]
    v_mfma_f32_16x16x32_bf16 v[32:35], v[192:195], v[80:83], v[32:35]
    v_mfma_f32_16x16x32_bf16 v[36:39], v[192:195], v[84:87], v[36:39]
    v_mfma_f32_16x16x32_bf16 v[40:43], v[192:195], v[88:91], v[40:43]
    v_mfma_f32_16x16x32_bf16 v[44:47], v[192:195], v[92:95], v[44:47]
    v_mfma_f32_16x16x32_bf16 v[48:51], v[192:195], v[96:99], v[48:51]
    v_mfma_f32_16x16x32_bf16 v[52:55], v[192:195], v[100:103], v[52:55]
    s_waitcnt lgkmcnt(0)
    s_add_u32 m0, s37, 3072
    s_mov_b32 s34, 340992
    buffer_load_dwordx4 v12, s[8:11], s34 offen lds
    s_waitcnt vmcnt(10)
    ds_read_b64_tr_b16 v[192:193], v9 offset:4096
    ds_read_b64_tr_b16 v[194:195], v9 offset:4352
    ds_read_b128 v[152:155], v14 offset:4208
    ds_read_b128 v[156:159], v14 offset:4800
    v_mfma_f32_16x16x32_bf16 v[16:19], v[196:199], v[68:71], v[16:19]
    v_mfma_f32_16x16x32_bf16 v[20:23], v[196:199], v[72:75], v[20:23]
    v_mfma_f32_16x16x32_bf16 v[24:27], v[196:199], v[76:79], v[24:27]
    v_mfma_f32_16x16x32_bf16 v[28:31], v[196:199], v[80:83], v[28:31]
    v_mfma_f32_16x16x32_bf16 v[32:35], v[196:199], v[84:87], v[32:35]
    v_mfma_f32_16x16x32_bf16 v[36:39], v[196:199], v[88:91], v[36:39]
    v_mfma_f32_16x16x32_bf16 v[40:43], v[196:199], v[92:95], v[40:43]
    v_mfma_f32_16x16x32_bf16 v[44:47], v[196:199], v[96:99], v[44:47]
    v_mfma_f32_16x16x32_bf16 v[48:51], v[196:199], v[100:103], v[48:51]
    v_mfma_f32_16x16x32_bf16 v[52:55], v[196:199], v[104:107], v[52:55]
    s_waitcnt lgkmcnt(0)
    s_add_u32 m0, s37, 4096
    s_mov_b32 s34, 423936
    buffer_load_dwordx4 v12, s[8:11], s34 offen lds
    s_waitcnt vmcnt(10)
    ds_read_b64_tr_b16 v[196:197], v9 offset:5120
    ds_read_b64_tr_b16 v[198:199], v9 offset:5376
    ds_read_b128 v[160:163], v14 offset:5392
    ds_read_b128 v[164:167], v14 offset:5984
    v_mfma_f32_16x16x32_bf16 v[16:19], v[192:195], v[72:75], v[16:19]
    v_mfma_f32_16x16x32_bf16 v[20:23], v[192:195], v[76:79], v[20:23]
    v_mfma_f32_16x16x32_bf16 v[24:27], v[192:195], v[80:83], v[24:27]
    v_mfma_f32_16x16x32_bf16 v[28:31], v[192:195], v[84:87], v[28:31]
    v_mfma_f32_16x16x32_bf16 v[32:35], v[192:195], v[88:91], v[32:35]
    v_mfma_f32_16x16x32_bf16 v[36:39], v[192:195], v[92:95], v[36:39]
    v_mfma_f32_16x16x32_bf16 v[40:43], v[192:195], v[96:99], v[40:43]
    v_mfma_f32_16x16x32_bf16 v[44:47], v[192:195], v[100:103], v[44:47]
    v_mfma_f32_16x16x32_bf16 v[48:51], v[192:195], v[104:107], v[48:51]
    v_mfma_f32_16x16x32_bf16 v[52:55], v[192:195], v[108:111], v[52:55]
    s_waitcnt lgkmcnt(0)
    s_add_u32 m0, s37, 5120
    s_mov_b32 s34, 506880
    buffer_load_dwordx4 v12, s[8:11], s34 offen lds
    s_waitcnt vmcnt(10)
    ds_read_b64_tr_b16 v[192:193], v9 offset:6144
    ds_read_b64_tr_b16 v[194:195], v9 offset:6400
    ds_read_b128 v[168:171], v14 offset:6576
    ds_read_b128 v[172:175], v14 offset:7168
    v_mfma_f32_16x16x32_bf16 v[16:19], v[196:199], v[76:79], v[16:19]
    v_mfma_f32_16x16x32_bf16 v[20:23], v[196:199], v[80:83], v[20:23]
    v_mfma_f32_16x16x32_bf16 v[24:27], v[196:199], v[84:87], v[24:27]
    v_mfma_f32_16x16x32_bf16 v[28:31], v[196:199], v[88:91], v[28:31]
    v_mfma_f32_16x16x32_bf16 v[32:35], v[196:199], v[92:95], v[32:35]
    v_mfma_f32_16x16x32_bf16 v[36:39], v[196:199], v[96:99], v[36:39]
    v_mfma_f32_16x16x32_bf16 v[40:43], v[196:199], v[100:103], v[40:43]
    v_mfma_f32_16x16x32_bf16 v[44:47], v[196:199], v[104:107], v[44:47]
    v_mfma_f32_16x16x32_bf16 v[48:51], v[196:199], v[108:111], v[48:51]
    v_mfma_f32_16x16x32_bf16 v[52:55], v[196:199], v[112:115], v[52:55]
    s_waitcnt lgkmcnt(0)
    s_add_u32 m0, s37, 6144
    s_mov_b32 s34, 0
    buffer_load_dwordx4 v13, s[8:11], s34 offen lds
    s_waitcnt vmcnt(10)
    ds_read_b64_tr_b16 v[196:197], v9 offset:7168
    ds_read_b64_tr_b16 v[198:199], v9 offset:7424
    ds_read_b128 v[176:179], v14 offset:7760
    ds_read_b128 v[180:183], v14 offset:8352
    v_mfma_f32_16x16x32_bf16 v[16:19], v[192:195], v[80:83], v[16:19]
    v_mfma_f32_16x16x32_bf16 v[20:23], v[192:195], v[84:87], v[20:23]
    v_mfma_f32_16x16x32_bf16 v[24:27], v[192:195], v[88:91], v[24:27]
    v_mfma_f32_16x16x32_bf16 v[28:31], v[192:195], v[92:95], v[28:31]
    v_mfma_f32_16x16x32_bf16 v[32:35], v[192:195], v[96:99], v[32:35]
    v_mfma_f32_16x16x32_bf16 v[36:39], v[192:195], v[100:103], v[36:39]
    v_mfma_f32_16x16x32_bf16 v[40:43], v[192:195], v[104:107], v[40:43]
    v_mfma_f32_16x16x32_bf16 v[44:47], v[192:195], v[108:111], v[44:47]
    v_mfma_f32_16x16x32_bf16 v[48:51], v[192:195], v[112:115], v[48:51]
    v_mfma_f32_16x16x32_bf16 v[52:55], v[192:195], v[116:119], v[52:55]
    s_waitcnt lgkmcnt(0)
    s_add_u32 m0, s37, 7168
    s_mov_b32 s34, 82944
    buffer_load_dwordx4 v13, s[8:11], s34 offen lds
    s_waitcnt vmcnt(10)
    ds_read_b64_tr_b16 v[192:193], v9 offset:8192
    ds_read_b64_tr_b16 v[194:195], v9 offset:8448
    ds_read_b128 v[184:187], v14 offset:8944
    ds_read_b128 v[188:191], v14 offset:9536
    v_mfma_f32_16x16x32_bf16 v[16:19], v[196:199], v[84:87], v[16:19]
    v_mfma_f32_16x16x32_bf16 v[20:23], v[196:199], v[88:91], v[20:23]
    v_mfma_f32_16x16x32_bf16 v[24:27], v[196:199], v[92:95], v[24:27]
    v_mfma_f32_16x16x32_bf16 v[28:31], v[196:199], v[96:99], v[28:31]
    v_mfma_f32_16x16x32_bf16 v[32:35], v[196:199], v[100:103], v[32:35]
    v_mfma_f32_16x16x32_bf16 v[36:39], v[196:199], v[104:107], v[36:39]
    v_mfma_f32_16x16x32_bf16 v[40:43], v[196:199], v[108:111], v[40:43]
    v_mfma_f32_16x16x32_bf16 v[44:47], v[196:199], v[112:115], v[44:47]
    v_mfma_f32_16x16x32_bf16 v[48:51], v[196:199], v[116:119], v[48:51]
    v_mfma_f32_16x16x32_bf16 v[52:55], v[196:199], v[120:123], v[52:55]
    s_waitcnt lgkmcnt(0)
    s_waitcnt vmcnt(9)
    ds_read_b64_tr_b16 v[196:197], v9 offset:9216
    ds_read_b64_tr_b16 v[198:199], v9 offset:9472
    ds_read_b128 v[56:59], v15 offset:0
    ds_read_b128 v[60:63], v15 offset:592
    ds_read_b128 v[64:67], v15 offset:1184
    ds_read_b128 v[68:71], v15 offset:1776
    ds_read_b128 v[72:75], v15 offset:2368
    ds_read_b128 v[76:79], v15 offset:2960
    v_mfma_f32_16x16x32_bf16 v[16:19], v[192:195], v[124:127], v[16:19]
    v_mfma_f32_16x16x32_bf16 v[20:23], v[192:195], v[128:131], v[20:23]
    v_mfma_f32_16x16x32_bf16 v[24:27], v[192:195], v[132:135], v[24:27]
    v_mfma_f32_16x16x32_bf16 v[28:31], v[192:195], v[136:139], v[28:31]
    v_mfma_f32_16x16x32_bf16 v[32:35], v[192:195], v[140:143], v[32:35]
    v_mfma_f32_16x16x32_bf16 v[36:39], v[192:195], v[144:147], v[36:39]
    v_mfma_f32_16x16x32_bf16 v[40:43], v[192:195], v[148:151], v[40:43]
    v_mfma_f32_16x16x32_bf16 v[44:47], v[192:195], v[152:155], v[44:47]
    v_mfma_f32_16x16x32_bf16 v[48:51], v[192:195], v[156:159], v[48:51]
    v_mfma_f32_16x16x32_bf16 v[52:55], v[192:195], v[160:163], v[52:55]
    s_waitcnt lgkmcnt(0)
    s_waitcnt vmcnt(7)
    ds_read_b64_tr_b16 v[192:193], v9 offset:0
    ds_read_b64_tr_b16 v[194:195], v9 offset:256
    ds_read_b128 v[80:83], v15 offset:3552
    ds_read_b128 v[84:87], v15 offset:4144
    ds_read_b128 v[88:91], v15 offset:4736
    ds_read_b128 v[92:95], v15 offset:5328
    ds_read_b128 v[96:99], v15 offset:5920
    v_mfma_f32_16x16x32_bf16 v[16:19], v[196:199], v[128:131], v[16:19]
    v_mfma_f32_16x16x32_bf16 v[20:23], v[196:199], v[132:135], v[20:23]
    v_mfma_f32_16x16x32_bf16 v[24:27], v[196:199], v[136:139], v[24:27]
    v_mfma_f32_16x16x32_bf16 v[28:31], v[196:199], v[140:143], v[28:31]
    v_mfma_f32_16x16x32_bf16 v[32:35], v[196:199], v[144:147], v[32:35]
    v_mfma_f32_16x16x32_bf16 v[36:39], v[196:199], v[148:151], v[36:39]
    v_mfma_f32_16x16x32_bf16 v[40:43], v[196:199], v[152:155], v[40:43]
    v_mfma_f32_16x16x32_bf16 v[44:47], v[196:199], v[156:159], v[44:47]
    v_mfma_f32_16x16x32_bf16 v[48:51], v[196:199], v[160:163], v[48:51]
    v_mfma_f32_16x16x32_bf16 v[52:55], v[196:199], v[164:167], v[52:55]
    s_waitcnt lgkmcnt(0)
    s_barrier
    v_add_u32 v200, 0, v254
    v_mul_u32_u24 v201, 27595, v200
    v_lshrrev_b32 v202, 27, v201
    v_lshrrev_b32 v201, 26, v201
    v_mad_u32_u24 v200, v202, s92, v200
    s_add_u32 m0, s38, 4864
    v_mad_i32_i24 v200, v201, s93, v200
    buffer_load_dwordx4 v200, s[12:15], s35 offen lds
    v_add_u32 v204, 4096, v254
    v_mul_u32_u24 v205, 27595, v204
    v_lshrrev_b32 v206, 27, v205
    v_lshrrev_b32 v205, 26, v205
    v_mad_u32_u24 v204, v206, s92, v204
    s_add_u32 m0, s38, 8960
    v_mad_i32_i24 v204, v205, s93, v204
    buffer_load_dwordx4 v204, s[12:15], s35 offen lds
    v_add_u32 v200, 8192, v254
    v_mul_u32_u24 v201, 27595, v200
    v_lshrrev_b32 v202, 27, v201
    v_lshrrev_b32 v201, 26, v201
    v_mad_u32_u24 v200, v202, s92, v200
    s_add_u32 m0, s38, 13056
    v_mad_i32_i24 v200, v201, s93, v200
    buffer_load_dwordx4 v200, s[12:15], s35 offen lds
    s_waitcnt vmcnt(9)
    ds_read_b64_tr_b16 v[196:197], v9 offset:1024
    ds_read_b64_tr_b16 v[198:199], v9 offset:1280
    v_mfma_f32_16x16x32_bf16 v[16:19], v[192:195], v[132:135], v[16:19]
    v_mfma_f32_16x16x32_bf16 v[20:23], v[192:195], v[136:139], v[20:23]
    v_mfma_f32_16x16x32_bf16 v[24:27], v[192:195], v[140:143], v[24:27]
    v_mfma_f32_16x16x32_bf16 v[28:31], v[192:195], v[144:147], v[28:31]
    v_mfma_f32_16x16x32_bf16 v[32:35], v[192:195], v[148:151], v[32:35]
    v_mfma_f32_16x16x32_bf16 v[36:39], v[192:195], v[152:155], v[36:39]
    v_mfma_f32_16x16x32_bf16 v[40:43], v[192:195], v[156:159], v[40:43]
    v_mfma_f32_16x16x32_bf16 v[44:47], v[192:195], v[160:163], v[44:47]
    v_mfma_f32_16x16x32_bf16 v[48:51], v[192:195], v[164:167], v[48:51]
    v_mfma_f32_16x16x32_bf16 v[52:55], v[192:195], v[168:171], v[52:55]
    s_waitcnt lgkmcnt(0)
    v_add_u32 v200, 12288, v254
    v_mul_u32_u24 v201, 27595, v200
    v_lshrrev_b32 v202, 27, v201
    v_lshrrev_b32 v201, 26, v201
    v_mad_u32_u24 v200, v202, s92, v200
    s_add_u32 m0, s38, 17152
    v_mad_i32_i24 v200, v201, s93, v200
    buffer_load_dwordx4 v200, s[12:15], s35 offen lds
    v_add_u32 v204, 16384, v254
    v_mul_u32_u24 v205, 27595, v204
    v_lshrrev_b32 v206, 27, v205
    v_lshrrev_b32 v205, 26, v205
    v_mad_u32_u24 v204, v206, s92, v204
    s_add_u32 m0, s38, 21248
    v_mad_i32_i24 v204, v205, s93, v204
    buffer_load_dwordx4 v204, s[12:15], s35 offen lds
    v_add_u32 v200, 20480, v254
    v_mul_u32_u24 v201, 27595, v200
    v_lshrrev_b32 v202, 27, v201
    v_lshrrev_b32 v201, 26, v201
    v_mad_u32_u24 v200, v202, s92, v200
    s_add_u32 m0, s38, 25344
    v_mad_i32_i24 v200, v201, s93, v200
    buffer_load_dwordx4 v200, s[12:15], s35 offen lds
    s_waitcnt vmcnt(11)
    ds_read_b64_tr_b16 v[192:193], v9 offset:2048
    ds_read_b64_tr_b16 v[194:195], v9 offset:2304
    v_mfma_f32_16x16x32_bf16 v[16:19], v[196:199], v[136:139], v[16:19]
    v_mfma_f32_16x16x32_bf16 v[20:23], v[196:199], v[140:143], v[20:23]
    v_mfma_f32_16x16x32_bf16 v[24:27], v[196:199], v[144:147], v[24:27]
    v_mfma_f32_16x16x32_bf16 v[28:31], v[196:199], v[148:151], v[28:31]
    v_mfma_f32_16x16x32_bf16 v[32:35], v[196:199], v[152:155], v[32:35]
    v_mfma_f32_16x16x32_bf16 v[36:39], v[196:199], v[156:159], v[36:39]
    v_mfma_f32_16x16x32_bf16 v[40:43], v[196:199], v[160:163], v[40:43]
    v_mfma_f32_16x16x32_bf16 v[44:47], v[196:199], v[164:167], v[44:47]
    v_mfma_f32_16x16x32_bf16 v[48:51], v[196:199], v[168:171], v[48:51]
    v_mfma_f32_16x16x32_bf16 v[52:55], v[196:199], v[172:175], v[52:55]
    s_waitcnt lgkmcnt(0)
    v_add_u32 v200, 24576, v254
    v_mul_u32_u24 v201, 27595, v200
    v_lshrrev_b32 v202, 27, v201
    v_lshrrev_b32 v201, 26, v201
    v_mad_u32_u24 v200, v202, s92, v200
    s_add_u32 m0, s38, 29440
    v_mad_i32_i24 v200, v201, s93, v200
    buffer_load_dwordx4 v200, s[12:15], s35 offen lds
    v_add_u32 v204, 28672, v254
    v_mul_u32_u24 v205, 27595, v204
    v_lshrrev_b32 v206, 27, v205
    v_lshrrev_b32 v205, 26, v205
    v_mad_u32_u24 v204, v206, s92, v204
    s_add_u32 m0, s38, 33536
    v_mad_i32_i24 v204, v205, s93, v204
    buffer_load_dwordx4 v204, s[12:15], s35 offen lds
    v_add_u32 v200, 32768, v254
    v_mul_u32_u24 v201, 27595, v200
    v_lshrrev_b32 v202, 27, v201
    v_lshrrev_b32 v201, 26, v201
    v_mad_u32_u24 v200, v202, s92, v200
    s_add_u32 m0, s38, 37632
    v_mad_i32_i24 v200, v201, s93, v200
    buffer_load_dwordx4 v200, s[12:15], s35 offen lds
    s_waitcnt vmcnt(13)
    ds_read_b64_tr_b16 v[196:197], v9 offset:3072
    ds_read_b64_tr_b16 v[198:199], v9 offset:3328
    v_mfma_f32_16x16x32_bf16 v[16:19], v[192:195], v[140:143], v[16:19]
    v_mfma_f32_16x16x32_bf16 v[20:23], v[192:195], v[144:147], v[20:23]
    v_mfma_f32_16x16x32_bf16 v[24:27], v[192:195], v[148:151], v[24:27]
    v_mfma_f32_16x16x32_bf16 v[28:31], v[192:195], v[152:155], v[28:31]
    v_mfma_f32_16x16x32_bf16 v[32:35], v[192:195], v[156:159], v[32:35]
    v_mfma_f32_16x16x32_bf16 v[36:39], v[192:195], v[160:163], v[36:39]
    v_mfma_f32_16x16x32_bf16 v[40:43], v[192:195], v[164:167], v[40:43]
    v_mfma_f32_16x16x32_bf16 v[44:47], v[192:195], v[168:171], v[44:47]
    v_mfma_f32_16x16x32_bf16 v[48:51], v[192:195], v[172:175], v[48:51]
    v_mfma_f32_16x16x32_bf16 v[52:55], v[192:195], v[176:179], v[52:55]
    s_waitcnt lgkmcnt(0)
    v_add_u32 v200, 36864, v254
    v_mul_u32_u24 v201, 27595, v200
    v_lshrrev_b32 v202, 27, v201
    v_lshrrev_b32 v201, 26, v201
    v_mad_u32_u24 v200, v202, s92, v200
    s_add_u32 m0, s38, 41728
    v_mad_i32_i24 v200, v201, s93, v200
    buffer_load_dwordx4 v200, s[12:15], s35 offen lds
    v_add_u32 v204, 40960, v254
    v_mul_u32_u24 v205, 27595, v204
    v_lshrrev_b32 v206, 27, v205
    v_lshrrev_b32 v205, 26, v205
    v_mad_u32_u24 v204, v206, s92, v204
    s_add_u32 m0, s38, 45824
    v_mad_i32_i24 v204, v205, s93, v204
    buffer_load_dwordx4 v204, s[12:15], s35 offen lds
    v_add_u32 v200, 45056, v254
    v_mul_u32_u24 v201, 27595, v200
    v_lshrrev_b32 v202, 27, v201
    v_lshrrev_b32 v201, 26, v201
    v_mad_u32_u24 v200, v202, s92, v200
    s_add_u32 m0, s38, 49920
    v_mad_i32_i24 v200, v201, s93, v200
    buffer_load_dwordx4 v200, s[12:15], s35 offen lds
    s_waitcnt vmcnt(15)
    ds_read_b64_tr_b16 v[192:193], v9 offset:4096
    ds_read_b64_tr_b16 v[194:195], v9 offset:4352
    v_mfma_f32_16x16x32_bf16 v[16:19], v[196:199], v[144:147], v[16:19]
    v_mfma_f32_16x16x32_bf16 v[20:23], v[196:199], v[148:151], v[20:23]
    v_mfma_f32_16x16x32_bf16 v[24:27], v[196:199], v[152:155], v[24:27]
    v_mfma_f32_16x16x32_bf16 v[28:31], v[196:199], v[156:159], v[28:31]
    v_mfma_f32_16x16x32_bf16 v[32:35], v[196:199], v[160:163], v[32:35]
    v_mfma_f32_16x16x32_bf16 v[36:39], v[196:199], v[164:167], v[36:39]
    v_mfma_f32_16x16x32_bf16 v[40:43], v[196:199], v[168:171], v[40:43]
    v_mfma_f32_16x16x32_bf16 v[44:47], v[196:199], v[172:175], v[44:47]
    v_mfma_f32_16x16x32_bf16 v[48:51], v[196:199], v[176:179], v[48:51]
    v_mfma_f32_16x16x32_bf16 v[52:55], v[196:199], v[180:183], v[52:55]
    s_waitcnt lgkmcnt(0)
    v_add_u32 v200, 49152, v254
    v_mul_u32_u24 v201, 27595, v200
    v_lshrrev_b32 v202, 27, v201
    v_lshrrev_b32 v201, 26, v201
    v_mad_u32_u24 v200, v202, s92, v200
    s_add_u32 m0, s38, 54016
    v_mad_i32_i24 v200, v201, s93, v200
    buffer_load_dwordx4 v200, s[12:15], s35 offen lds
    v_add_u32 v204, 53248, v254
    v_mul_u32_u24 v205, 27595, v204
    v_lshrrev_b32 v206, 27, v205
    v_lshrrev_b32 v205, 26, v205
    v_mad_u32_u24 v204, v206, s92, v204
    s_add_u32 m0, s38, 58112
    v_mad_i32_i24 v204, v205, s93, v204
    buffer_load_dwordx4 v204, s[12:15], s35 offen lds
    v_add_u32 v200, 57344, v254
    v_mul_u32_u24 v201, 27595, v200
    v_lshrrev_b32 v202, 27, v201
    v_lshrrev_b32 v201, 26, v201
    v_mad_u32_u24 v200, v202, s92, v200
    s_add_u32 m0, s38, 62208
    v_mad_i32_i24 v200, v201, s93, v200
    buffer_load_dwordx4 v200, s[12:15], s35 offen lds
    s_waitcnt vmcnt(17)
    ds_read_b64_tr_b16 v[196:197], v9 offset:5120
    ds_read_b64_tr_b16 v[198:199], v9 offset:5376
    v_mfma_f32_16x16x32_bf16 v[16:19], v[192:195], v[148:151], v[16:19]
    v_mfma_f32_16x16x32_bf16 v[20:23], v[192:195], v[152:155], v[20:23]
    v_mfma_f32_16x16x32_bf16 v[24:27], v[192:195], v[156:159], v[24:27]
    v_mfma_f32_16x16x32_bf16 v[28:31], v[192:195], v[160:163], v[28:31]
    v_mfma_f32_16x16x32_bf16 v[32:35], v[192:195], v[164:167], v[32:35]
    v_mfma_f32_16x16x32_bf16 v[36:39], v[192:195], v[168:171], v[36:39]
    v_mfma_f32_16x16x32_bf16 v[40:43], v[192:195], v[172:175], v[40:43]
    v_mfma_f32_16x16x32_bf16 v[44:47], v[192:195], v[176:179], v[44:47]
    v_mfma_f32_16x16x32_bf16 v[48:51], v[192:195], v[180:183], v[48:51]
    v_mfma_f32_16x16x32_bf16 v[52:55], v[192:195], v[184:187], v[52:55]
    s_waitcnt lgkmcnt(0)
    v_add_u32 v200, 61440, v254
    v_mul_u32_u24 v201, 27595, v200
    v_lshrrev_b32 v202, 27, v201
    v_lshrrev_b32 v201, 26, v201
    v_mad_u32_u24 v200, v202, s92, v200
    s_add_u32 m0, s38, 66304
    v_mad_i32_i24 v200, v201, s93, v200
    buffer_load_dwordx4 v200, s[12:15], s35 offen lds
    v_add_u32 v204, 65536, v254
    v_mul_u32_u24 v205, 27595, v204
    v_lshrrev_b32 v206, 27, v205
    v_lshrrev_b32 v205, 26, v205
    v_mad_u32_u24 v204, v206, s92, v204
    s_add_u32 m0, s38, 70400
    v_mad_i32_i24 v204, v205, s93, v204
    buffer_load_dwordx4 v204, s[12:15], s35 offen lds
    v_add_u32 v200, 69632, v254
    v_mul_u32_u24 v201, 27595, v200
    v_lshrrev_b32 v202, 27, v201
    v_lshrrev_b32 v201, 26, v201
    v_mad_u32_u24 v200, v202, s92, v200
    s_add_u32 m0, s38, 74496
    v_mad_i32_i24 v200, v201, s93, v200
    buffer_load_dwordx4 v200, s[12:15], s35 offen lds
    s_waitcnt vmcnt(19)
    ds_read_b64_tr_b16 v[192:193], v9 offset:6144
    ds_read_b64_tr_b16 v[194:195], v9 offset:6400
    v_mfma_f32_16x16x32_bf16 v[16:19], v[196:199], v[152:155], v[16:19]
    v_mfma_f32_16x16x32_bf16 v[20:23], v[196:199], v[156:159], v[20:23]
    v_mfma_f32_16x16x32_bf16 v[24:27], v[196:199], v[160:163], v[24:27]
    v_mfma_f32_16x16x32_bf16 v[28:31], v[196:199], v[164:167], v[28:31]
    v_mfma_f32_16x16x32_bf16 v[32:35], v[196:199], v[168:171], v[32:35]
    v_mfma_f32_16x16x32_bf16 v[36:39], v[196:199], v[172:175], v[36:39]
    v_mfma_f32_16x16x32_bf16 v[40:43], v[196:199], v[176:179], v[40:43]
    v_mfma_f32_16x16x32_bf16 v[44:47], v[196:199], v[180:183], v[44:47]
    v_mfma_f32_16x16x32_bf16 v[48:51], v[196:199], v[184:187], v[48:51]
    v_mfma_f32_16x16x32_bf16 v[52:55], v[196:199], v[188:191], v[52:55]
    s_waitcnt lgkmcnt(0)
    s_waitcnt vmcnt(18)
    ds_read_b64_tr_b16 v[196:197], v9 offset:7168
    ds_read_b64_tr_b16 v[198:199], v9 offset:7424
    v_mfma_f32_16x16x32_bf16 v[16:19], v[192:195], v[56:59], v[16:19]
    v_mfma_f32_16x16x32_bf16 v[20:23], v[192:195], v[60:63], v[20:23]
    v_mfma_f32_16x16x32_bf16 v[24:27], v[192:195], v[64:67], v[24:27]
    v_mfma_f32_16x16x32_bf16 v[28:31], v[192:195], v[68:71], v[28:31]
    v_mfma_f32_16x16x32_bf16 v[32:35], v[192:195], v[72:75], v[32:35]
    v_mfma_f32_16x16x32_bf16 v[36:39], v[192:195], v[76:79], v[36:39]
    v_mfma_f32_16x16x32_bf16 v[40:43], v[192:195], v[80:83], v[40:43]
    v_mfma_f32_16x16x32_bf16 v[44:47], v[192:195], v[84:87], v[44:47]
    v_mfma_f32_16x16x32_bf16 v[48:51], v[192:195], v[88:91], v[48:51]
    v_mfma_f32_16x16x32_bf16 v[52:55], v[192:195], v[92:95], v[52:55]
    s_waitcnt lgkmcnt(0)
    v_mfma_f32_16x16x32_bf16 v[16:19], v[196:199], v[60:63], v[16:19]
    v_mfma_f32_16x16x32_bf16 v[20:23], v[196:199], v[64:67], v[20:23]
    v_mfma_f32_16x16x32_bf16 v[24:27], v[196:199], v[68:71], v[24:27]
    v_mfma_f32_16x16x32_bf16 v[28:31], v[196:199], v[72:75], v[28:31]
    v_mfma_f32_16x16x32_bf16 v[32:35], v[196:199], v[76:79], v[32:35]
    v_mfma_f32_16x16x32_bf16 v[36:39], v[196:199], v[80:83], v[36:39]
    v_mfma_f32_16x16x32_bf16 v[40:43], v[196:199], v[84:87], v[40:43]
    v_mfma_f32_16x16x32_bf16 v[44:47], v[196:199], v[88:91], v[44:47]
    v_mfma_f32_16x16x32_bf16 v[48:51], v[196:199], v[92:95], v[48:51]
    v_mfma_f32_16x16x32_bf16 v[52:55], v[196:199], v[96:99], v[52:55]
    v_and_b32 v6, 1, v1
    s_lshl_b32 s34, s28, 3
    v_mov_b32 v7, s34
    v_mov_b32 v8, 248
    v_cmp_eq_u32 vcc, 0, v6
    v_lshlrev_b32 v6, 4, v1
    v_add_u32 v9, s37, v6
    v_cndmask_b32 v249, v8, v7, vcc
    v_mov_b32 v7, 9
    v_mov_b32 v8, 1
    v_cndmask_b32 v252, v8, v7, vcc

    buffer_load_dword v250, v249, s[40:43], 0 offen sc1
    ds_write_b128 v9, v[16:19] offset:0
    ds_write_b128 v9, v[20:23] offset:1024
    ds_write_b128 v9, v[24:27] offset:2048
    ds_write_b128 v9, v[28:31] offset:3072
    ds_write_b128 v9, v[32:35] offset:4096
    ds_write_b128 v9, v[36:39] offset:5120
    ds_write_b128 v9, v[40:43] offset:6144
    ds_write_b128 v9, v[44:47] offset:7168
    ds_write_b128 v9, v[48:51] offset:8192
    ds_write_b128 v9, v[52:55] offset:9216
    v_add_u32 v8, 102400, v6
    v_add_u32 v8, s38, v8
    s_lshr_b32 s34, s32, 1
    s_lshl_b32 s34, s34, 10
    s_and_b32 s36, s32, 1
    s_lshl_b32 s36, s36, 3
    s_add_u32 s34, s34, s36
    s_add_u32 s34, s34, 110592
    v_add_u32 v9, s34, v6
    v_mov_b32 v10, 0xc0135761
    v_mov_b32 v11, 0xbdd2d3e8
    v_mul_u32_u24 v12, 10, v2
    s_lshl_b32 s34, s33, 1
    s_sub_u32 s34, s34, 8
    s_movk_i32 s46, 2000

    s_add_u32 s47, s32, 0
    v_add_u32 v13, s47, v12
    v_add_u32 v6, s34, v13
    v_cmp_gt_u32 s[26:27], s46, v6
    v_lshrrev_b32 v7, 1, v13
    v_mul_u32_u24 v7, 96, v7
    v_and_b32 v13, 1, v13
    v_lshl_add_u32 v7, v13, 5, v7
    v_lshl_add_u32 v7, v3, 3, v7
    v_add_u32 v200, 143360, v7
    s_add_u32 s47, s32, 4
    v_add_u32 v13, s47, v12
    v_add_u32 v6, s34, v13
    v_cmp_gt_u32 s[94:95], s46, v6
    v_lshrrev_b32 v7, 1, v13
    v_mul_u32_u24 v7, 96, v7
    v_and_b32 v13, 1, v13
    v_lshl_add_u32 v7, v13, 5, v7
    v_lshl_add_u32 v7, v3, 3, v7
    v_add_u32 v201, 143360, v7
    s_lshr_b32 s47, s32, 1
    s_add_u32 s47, s47, 8
    v_add_u32 v13, s47, v12
    v_add_u32 v6, s34, v13
    v_cmp_gt_u32 s[56:57], s46, v6
    v_lshrrev_b32 v7, 1, v13
    v_mul_u32_u24 v7, 96, v7
    v_and_b32 v13, 1, v13
    v_lshl_add_u32 v7, v13, 5, v7
    v_lshl_add_u32 v7, v3, 3, v7
    v_add_u32 v202, 143360, v7
    s_lshr_b32 s47, s36, 1
    v_add_u32 v202, s47, v202
    v_lshrrev_b32 v14, 1, v3
    v_mul_u32_u24 v14, 4864, v14
    v_and_b32 v15, 1, v3
    v_mul_u32_u24 v15, 2432, v15
    v_add_u32 v14, v14, v15
    v_mul_u32_u24 v15, 288, v4
    v_add_u32 v14, v14, v15
    v_lshl_add_u32 v203, v5, 3, v14
    v_add_u32 v203, 256, v203
    v_add_u32 v204, 38912, v203
    v_lshl_add_u32 v205, v5, 3, v14
    s_lshl_b32 s47, s32, 6
    v_add_u32 v205, s47, v205
    v_add_u32 v206, 38912, v205

    s_waitcnt vmcnt(1) lgkmcnt(0)
    s_barrier
    ds_read_b128 v[152:155], v8 offset:0
    ds_read_b128 v[156:159], v8 offset:10240
    ds_read_b128 v[160:163], v8 offset:20480
    ds_read_b128 v[164:167], v8 offset:30720
    ds_read_b128 v[168:171], v8 offset:4096
    ds_read_b128 v[172:175], v8 offset:14336
    ds_read_b128 v[176:179], v8 offset:24576
    ds_read_b128 v[180:183], v8 offset:34816
    ds_read_b64 v[184:185], v9 offset:0
    ds_read_b64 v[186:187], v9 offset:10240
    ds_read_b64 v[188:189], v9 offset:20480
    ds_read_b64 v[190:191], v9 offset:30720
    v_add_u32 v14, 0, v254
    v_mul_u32_u24 v15, 27595, v14
    v_lshrrev_b32 v15, 26, v15
    s_add_u32 m0, s38, 78848
    v_mad_i32_i24 v14, v15, s93, v14
    buffer_load_dwordx4 v14, s[80:83], 0 offen lds
    v_add_u32 v14, 4096, v254
    v_mul_u32_u24 v15, 27595, v14
    v_lshrrev_b32 v15, 26, v15
    s_add_u32 m0, s38, 82944
    v_mad_i32_i24 v14, v15, s93, v14
    buffer_load_dwordx4 v14, s[80:83], 0 offen lds
    v_add_u32 v14, 8192, v254
    v_mul_u32_u24 v15, 27595, v14
    v_lshrrev_b32 v15, 26, v15
    s_add_u32 m0, s38, 87040
    v_mad_i32_i24 v14, v15, s93, v14
    buffer_load_dwordx4 v14, s[80:83], 0 offen lds
    v_add_u32 v14, 12288, v254
    v_mul_u32_u24 v15, 27595, v14
    v_lshrrev_b32 v15, 26, v15
    s_add_u32 m0, s38, 91136
    v_mad_i32_i24 v14, v15, s93, v14
    buffer_load_dwordx4 v14, s[80:83], 0 offen lds
    v_add_u32 v14, 16384, v254
    v_mul_u32_u24 v15, 27595, v14
    v_lshrrev_b32 v15, 26, v15
    s_add_u32 m0, s38, 95232
    v_mad_i32_i24 v14, v15, s93, v14
    buffer_load_dwordx4 v14, s[80:83], 0 offen lds
    s_waitcnt lgkmcnt(8)
    v_add_f32 v152, v152, v156
    v_add_f32 v153, v153, v157
    v_add_f32 v154, v154, v158
    v_add_f32 v155, v155, v159
    v_add_f32 v160, v160, v164
    v_add_f32 v161, v161, v165
    v_add_f32 v162, v162, v166
    v_add_f32 v163, v163, v167
    v_add_f32 v152, v152, v160
    v_add_f32 v153, v153, v161
    v_add_f32 v154, v154, v162
    v_add_f32 v155, v155, v163
    s_waitcnt lgkmcnt(0)
    v_mul_f32 v156, v152, v152
    v_mul_f32 v157, v153, v153
    v_mul_f32 v158, v154, v154
    ds_read_b64_tr_b16 v[56:57], v205 offset:0
    v_mul_f32 v159, v155, v155
    v_fma_f32 v156, v156, v11, v10
    v_fma_f32 v157, v157, v11, v10
    ds_read_b64_tr_b16 v[58:59], v205 offset:1152
    v_fma_f32 v158, v158, v11, v10
    v_fma_f32 v159, v159, v11, v10
    v_mul_f32 v156, v156, v152
    ds_read_b64_tr_b16 v[60:61], v205 offset:9728
    v_mul_f32 v157, v157, v153
    v_mul_f32 v158, v158, v154
    v_mul_f32 v159, v159, v155
    ds_read_b64_tr_b16 v[62:63], v205 offset:10880
    v_exp_f32 v156, v156
    v_exp_f32 v157, v157
    v_exp_f32 v158, v158
    ds_read_b64_tr_b16 v[64:65], v205 offset:19456
    v_exp_f32 v159, v159
    v_add_f32 v156, 1.0, v156
    v_add_f32 v157, 1.0, v157
    ds_read_b64_tr_b16 v[66:67], v205 offset:20608
    v_add_f32 v158, 1.0, v158
    v_add_f32 v159, 1.0, v159
    v_rcp_f32 v156, v156
    ds_read_b64_tr_b16 v[68:69], v205 offset:29184
    v_rcp_f32 v157, v157
    v_rcp_f32 v158, v158
    v_rcp_f32 v159, v159
    ds_read_b64_tr_b16 v[70:71], v205 offset:30336
    v_mul_f32 v152, v152, v156
    v_mul_f32 v153, v153, v157
    v_mul_f32 v154, v154, v158
    ds_read_b64_tr_b16 v[72:73], v206 offset:0
    v_mul_f32 v155, v155, v159
    v_cvt_pk_bf16_f32 v156, v152, v153
    v_cvt_pk_bf16_f32 v157, v154, v155
    ds_read_b64_tr_b16 v[74:75], v206 offset:1152
    s_nop 0
    v_cndmask_b32 v156, 0, v156, s[26:27]
    v_cndmask_b32 v157, 0, v157, s[26:27]
    ds_write_b64 v200, v[156:157]
    v_add_f32 v168, v168, v172
    ds_read_b64_tr_b16 v[76:77], v206 offset:9728
    v_add_f32 v169, v169, v173
    v_add_f32 v170, v170, v174
    v_add_f32 v171, v171, v175
    ds_read_b64_tr_b16 v[78:79], v206 offset:10880
    v_add_f32 v176, v176, v180
    v_add_f32 v177, v177, v181
    v_add_f32 v178, v178, v182
    ds_read_b64_tr_b16 v[80:81], v206 offset:19456
    v_add_f32 v179, v179, v183
    v_add_f32 v168, v168, v176
    v_add_f32 v169, v169, v177
    ds_read_b64_tr_b16 v[82:83], v206 offset:20608
    v_add_f32 v170, v170, v178
    v_add_f32 v171, v171, v179
    v_mul_f32 v172, v168, v168
    ds_read_b64_tr_b16 v[84:85], v206 offset:29184
    v_mul_f32 v173, v169, v169
    v_mul_f32 v174, v170, v170
    v_mul_f32 v175, v171, v171
    ds_read_b64_tr_b16 v[86:87], v206 offset:30336
    v_fma_f32 v172, v172, v11, v10
    v_fma_f32 v173, v173, v11, v10
    v_fma_f32 v174, v174, v11, v10
    ds_read_b64_tr_b16 v[88:89], v205 offset:32
    v_fma_f32 v175, v175, v11, v10
    v_mul_f32 v172, v172, v168
    v_mul_f32 v173, v173, v169
    ds_read_b64_tr_b16 v[90:91], v205 offset:1184
    v_mul_f32 v174, v174, v170
    v_mul_f32 v175, v175, v171
    v_exp_f32 v172, v172
    ds_read_b64_tr_b16 v[92:93], v205 offset:9760
    v_exp_f32 v173, v173
    v_exp_f32 v174, v174
    v_exp_f32 v175, v175
    ds_read_b64_tr_b16 v[94:95], v205 offset:10912
    v_add_f32 v172, 1.0, v172
    v_add_f32 v173, 1.0, v173
    v_add_f32 v174, 1.0, v174
    ds_read_b64_tr_b16 v[96:97], v205 offset:19488
    v_add_f32 v175, 1.0, v175
    v_rcp_f32 v172, v172
    v_rcp_f32 v173, v173
    ds_read_b64_tr_b16 v[98:99], v205 offset:20640
    v_rcp_f32 v174, v174
    v_rcp_f32 v175, v175
    v_mul_f32 v168, v168, v172
    ds_read_b64_tr_b16 v[100:101], v205 offset:29216
    v_mul_f32 v169, v169, v173
    v_mul_f32 v170, v170, v174
    v_mul_f32 v171, v171, v175
    ds_read_b64_tr_b16 v[102:103], v205 offset:30368
    v_cvt_pk_bf16_f32 v172, v168, v169
    v_cvt_pk_bf16_f32 v173, v170, v171
    s_nop 0
    v_cndmask_b32 v172, 0, v172, s[94:95]
    ds_read_b64_tr_b16 v[104:105], v206 offset:32
    v_cndmask_b32 v173, 0, v173, s[94:95]
    ds_write_b64 v201, v[172:173]
    v_add_f32 v184, v184, v186
    v_add_f32 v185, v185, v187
    ds_read_b64_tr_b16 v[106:107], v206 offset:1184
    v_add_f32 v188, v188, v190
    v_add_f32 v189, v189, v191
    v_add_f32 v184, v184, v188
    ds_read_b64_tr_b16 v[108:109], v206 offset:9760
    v_add_f32 v185, v185, v189
    v_mul_f32 v186, v184, v184
    v_mul_f32 v187, v185, v185
    ds_read_b64_tr_b16 v[110:111], v206 offset:10912
    v_fma_f32 v186, v186, v11, v10
    v_fma_f32 v187, v187, v11, v10
    v_mul_f32 v186, v186, v184
    ds_read_b64_tr_b16 v[112:113], v206 offset:19488
    v_mul_f32 v187, v187, v185
    v_exp_f32 v186, v186
    v_exp_f32 v187, v187
    ds_read_b64_tr_b16 v[114:115], v206 offset:20640
    v_add_f32 v186, 1.0, v186
    v_add_f32 v187, 1.0, v187
    v_rcp_f32 v186, v186
    ds_read_b64_tr_b16 v[116:117], v206 offset:29216
    v_rcp_f32 v187, v187
    v_mul_f32 v184, v184, v186
    v_mul_f32 v185, v185, v187
    ds_read_b64_tr_b16 v[118:119], v206 offset:30368
    v_cvt_pk_bf16_f32 v188, v184, v185
    s_nop 0
    v_cndmask_b32 v188, 0, v188, s[56:57]
    ds_write_b32 v202, v188
    v_mul_u32_u24 v6, 480, v2
    v_lshl_add_u32 v6, v3, 4, v6
    v_add_u32 v6, 143360, v6
    s_mul_i32 s34, s32, 96
    v_add_u32 v15, s34, v6
    v_mov_b32 v53, v203
    v_mov_b32 v54, v204

    s_waitcnt vmcnt(5) lgkmcnt(0)
    s_barrier
    ds_read_b128 v[152:155], v6 offset:0
    ds_read_b128 v[168:171], v6 offset:384
    ds_read_b128 v[156:159], v6 offset:96
    ds_read_b128 v[172:175], v6 offset:480
    ds_read_b128 v[160:163], v6 offset:192
    ds_read_b128 v[176:179], v6 offset:576
    ds_read_b128 v[164:167], v6 offset:288
    ds_read_b128 v[180:183], v6 offset:672
    ds_read_b128 v[184:187], v6 offset:768
    ds_read_b128 v[188:191], v6 offset:864
    ds_read_b128 v[192:195], v6 offset:960
    ds_read_b128 v[196:199], v6 offset:1056
    v_cmp_lt_u32 vcc, 31, v1
    v_cndmask_b32 v56, 0, v56, vcc
    v_cndmask_b32 v57, 0, v57, vcc
    v_cndmask_b32 v58, 0, v58, vcc
    v_cndmask_b32 v59, 0, v59, vcc
    v_cndmask_b32 v88, 0, v88, vcc
    v_cndmask_b32 v89, 0, v89, vcc
    v_cndmask_b32 v90, 0, v90, vcc
    v_cndmask_b32 v91, 0, v91, vcc
    s_waitcnt lgkmcnt(10)
    v_mfma_f32_16x16x32_bf16 v[200:203], v[56:59], v[152:155], 0
    v_add_u32 v9, 20480, v254
    v_mul_u32_u24 v10, 27595, v9
    v_mfma_f32_16x16x32_bf16 v[220:223], v[88:91], v[152:155], 0
    v_lshrrev_b32 v10, 26, v10
    s_add_u32 m0, s38, 99328
    v_mad_i32_i24 v9, v10, s93, v9
    v_mfma_f32_16x16x32_bf16 v[216:219], v[56:59], v[168:171], 0
    buffer_load_dwordx4 v9, s[80:83], 0 offen lds
    v_add_u32 v9, 24576, v254
    s_waitcnt lgkmcnt(8)
    v_mfma_f32_16x16x32_bf16 v[200:203], v[60:63], v[156:159], v[200:203]
    v_mul_u32_u24 v10, 27595, v9
    v_lshrrev_b32 v10, 26, v10
    v_mfma_f32_16x16x32_bf16 v[220:223], v[92:95], v[156:159], v[220:223]
    s_add_u32 m0, s38, 103424
    v_mad_i32_i24 v9, v10, s93, v9
    buffer_load_dwordx4 v9, s[80:83], 0 offen lds
    v_mfma_f32_16x16x32_bf16 v[216:219], v[60:63], v[172:175], v[216:219]
    v_add_u32 v9, 28672, v254
    v_mul_u32_u24 v10, 27595, v9
    s_waitcnt lgkmcnt(6)
    v_mfma_f32_16x16x32_bf16 v[200:203], v[64:67], v[160:163], v[200:203]
    v_lshrrev_b32 v10, 26, v10
    s_add_u32 m0, s38, 107520
    v_mad_i32_i24 v9, v10, s93, v9
    v_mfma_f32_16x16x32_bf16 v[220:223], v[96:99], v[160:163], v[220:223]
    buffer_load_dwordx4 v9, s[80:83], 0 offen lds
    v_add_u32 v9, 32768, v254
    v_mfma_f32_16x16x32_bf16 v[216:219], v[64:67], v[176:179], v[216:219]
    v_mul_u32_u24 v10, 27595, v9
    v_lshrrev_b32 v10, 26, v10
    s_waitcnt lgkmcnt(4)
    v_mfma_f32_16x16x32_bf16 v[200:203], v[68:71], v[164:167], v[200:203]
    s_add_u32 m0, s38, 111616
    v_mad_i32_i24 v9, v10, s93, v9
    buffer_load_dwordx4 v9, s[80:83], 0 offen lds
    v_mfma_f32_16x16x32_bf16 v[220:223], v[100:103], v[164:167], v[220:223]
    v_add_u32 v9, 36864, v254
    v_mul_u32_u24 v10, 27595, v9
    v_mfma_f32_16x16x32_bf16 v[216:219], v[68:71], v[180:183], v[216:219]
    v_lshrrev_b32 v10, 26, v10
    s_add_u32 m0, s38, 115712
    v_mad_i32_i24 v9, v10, s93, v9
    s_waitcnt lgkmcnt(3)
    v_mfma_f32_16x16x32_bf16 v[200:203], v[72:75], v[168:171], v[200:203]
    buffer_load_dwordx4 v9, s[80:83], 0 offen lds
    v_add_u32 v9, 40960, v254
    v_mfma_f32_16x16x32_bf16 v[220:223], v[104:107], v[168:171], v[220:223]
    v_mul_u32_u24 v10, 27595, v9
    v_lshrrev_b32 v10, 26, v10
    v_mfma_f32_16x16x32_bf16 v[216:219], v[72:75], v[184:187], v[216:219]
    s_add_u32 m0, s38, 119808
    v_mad_i32_i24 v9, v10, s93, v9
    buffer_load_dwordx4 v9, s[80:83], 0 offen lds
    s_waitcnt lgkmcnt(2)
    v_mfma_f32_16x16x32_bf16 v[200:203], v[76:79], v[172:175], v[200:203]
    s_mul_i32 s34, s30, 1008
    s_add_u32 s34, s34, s33
    s_mul_i32 s34, s34, 2592
    s_mul_i32 s35, s29, 288
    s_add_u32 s34, s34, s35
    v_mul_u32_u24 v14, 5, v2
    v_mul_u32_u24 v50, 12960, v2
    v_mfma_f32_16x16x32_bf16 v[220:223], v[108:111], v[172:175], v[220:223]
    v_add_u32 v50, s34, v50
    v_and_b32 v48, 1, v3
    v_mfma_f32_16x16x32_bf16 v[216:219], v[76:79], v[188:191], v[216:219]
    v_lshl_add_u32 v48, v48, 5, v50
    v_lshrrev_b32 v51, 1, v3
    s_waitcnt lgkmcnt(1)
    v_mfma_f32_16x16x32_bf16 v[200:203], v[80:83], v[176:179], v[200:203]
    v_lshl_add_u32 v48, v51, 4, v48
    s_lshl_b32 s35, s32, 6
    v_add_u32 v48, s35, v48
    v_mfma_f32_16x16x32_bf16 v[220:223], v[112:115], v[176:179], v[220:223]
    v_lshl_add_u32 v49, v3, 3, v50
    v_add_u32 v49, 256, v49
    v_mfma_f32_16x16x32_bf16 v[216:219], v[80:83], v[192:195], v[216:219]
    v_mov_b32 v50, 0x80000000
    v_add_u32 v51, 0, v14
    s_waitcnt lgkmcnt(0)
    v_mfma_f32_16x16x32_bf16 v[200:203], v[84:87], v[180:183], v[200:203]
    v_cmp_gt_u32 vcc, 72, v51
    v_add_u32 v52, 0, v48
    v_mfma_f32_16x16x32_bf16 v[220:223], v[116:119], v[180:183], v[220:223]
    s_nop 0
    v_cndmask_b32 v16, v50, v52, vcc
    v_add_u32 v51, 1, v14
    v_mfma_f32_16x16x32_bf16 v[216:219], v[84:87], v[196:199], v[216:219]
    v_cmp_gt_u32 vcc, 72, v51
    v_add_u32 v52, 2592, v48
    ds_read_b64_tr_b16 v[120:121], v53 offset:0
    ds_read_b64_tr_b16 v[122:123], v53 offset:1152
    ds_read_b128 a[0:3], v15 offset:0
    v_mfma_f32_16x16x32_bf16 v[204:207], v[56:59], v[156:159], 0
    s_nop 0
    v_cndmask_b32 v17, v50, v52, vcc
    v_add_u32 v51, 2, v14
    v_mfma_f32_16x16x32_bf16 v[224:227], v[88:91], v[156:159], 0
    v_cmp_gt_u32 vcc, 72, v51
    v_add_u32 v52, 5184, v48
    v_mfma_f32_16x16x32_bf16 v[236:239], v[88:91], v[168:171], 0
    s_nop 0
    v_cndmask_b32 v18, v50, v52, vcc
    v_add_u32 v51, 3, v14
    ds_read_b64_tr_b16 v[124:125], v53 offset:9728
    ds_read_b64_tr_b16 v[126:127], v53 offset:10880
    ds_read_b128 a[4:7], v15 offset:96
    v_mfma_f32_16x16x32_bf16 v[204:207], v[60:63], v[160:163], v[204:207]
    v_cmp_gt_u32 vcc, 72, v51
    v_add_u32 v52, 7776, v48
    v_mfma_f32_16x16x32_bf16 v[224:227], v[92:95], v[160:163], v[224:227]
    s_nop 0
    v_cndmask_b32 v19, v50, v52, vcc
    v_add_u32 v51, 4, v14
    v_mfma_f32_16x16x32_bf16 v[236:239], v[92:95], v[172:175], v[236:239]
    v_cmp_gt_u32 vcc, 72, v51
    v_add_u32 v52, 10368, v48
    ds_read_b64_tr_b16 v[128:129], v53 offset:19456
    ds_read_b64_tr_b16 v[130:131], v53 offset:20608
    ds_read_b128 a[8:11], v15 offset:192
    v_mfma_f32_16x16x32_bf16 v[204:207], v[64:67], v[164:167], v[204:207]
    s_nop 0
    v_cndmask_b32 v20, v50, v52, vcc
    v_add_u32 v51, s32, v14
    v_mfma_f32_16x16x32_bf16 v[224:227], v[96:99], v[164:167], v[224:227]
    v_cmp_gt_u32 vcc, 72, v51
    s_mul_i32 s35, s32, 2592
    v_add_u32 v52, s35, v49
    v_mfma_f32_16x16x32_bf16 v[236:239], v[96:99], v[176:179], v[236:239]
    v_add_u32 v51, 4, v14
    v_cndmask_b32 v21, v50, v52, vcc
    ds_read_b64_tr_b16 v[132:133], v53 offset:29184
    ds_read_b64_tr_b16 v[134:135], v53 offset:30336
    ds_read_b128 a[12:15], v15 offset:288
    v_mfma_f32_16x16x32_bf16 v[204:207], v[68:71], v[168:171], v[204:207]
    v_cmp_gt_u32 vcc, 72, v51
    v_add_u32 v52, 10368, v49
    v_mfma_f32_16x16x32_bf16 v[224:227], v[100:103], v[168:171], v[224:227]
    s_cmp_eq_u32 s32, 0
    s_cselect_b64 s[46:47], -1, 0
    s_and_b64 vcc, vcc, s[46:47]
    v_cndmask_b32 v22, v50, v52, vcc
    v_cvt_pk_bf16_f32 v24, v200, v201
    v_mfma_f32_16x16x32_bf16 v[236:239], v[100:103], v[180:183], v[236:239]
    v_cvt_pk_bf16_f32 v26, v220, v221
    v_cvt_pk_bf16_f32 v25, v202, v203
    ds_read_b64_tr_b16 v[136:137], v54 offset:0
    ds_read_b64_tr_b16 v[138:139], v54 offset:1152
    ds_read_b128 a[16:19], v15 offset:384
    v_mfma_f32_16x16x32_bf16 v[204:207], v[72:75], v[172:175], v[204:207]
    v_cvt_pk_bf16_f32 v27, v222, v223
    s_nop 1
    v_permlane16_swap_b32 v24, v26
    v_mfma_f32_16x16x32_bf16 v[224:227], v[104:107], v[172:175], v[224:227]
    v_permlane16_swap_b32 v25, v27
    s_nop 1
    buffer_store_dwordx4 v[24:27], v16, s[16:19], 0 offen sc1
    v_mfma_f32_16x16x32_bf16 v[236:239], v[104:107], v[184:187], v[236:239]
    ds_read_b64_tr_b16 v[140:141], v54 offset:9728
    ds_read_b64_tr_b16 v[142:143], v54 offset:10880
    ds_read_b128 a[20:23], v15 offset:480
    v_mfma_f32_16x16x32_bf16 v[204:207], v[76:79], v[176:179], v[204:207]
    v_mfma_f32_16x16x32_bf16 v[224:227], v[108:111], v[176:179], v[224:227]
    v_mfma_f32_16x16x32_bf16 v[236:239], v[108:111], v[188:191], v[236:239]
    ds_read_b64_tr_b16 v[144:145], v54 offset:19456
    ds_read_b64_tr_b16 v[146:147], v54 offset:20608
    ds_read_b128 a[24:27], v15 offset:576
    v_mfma_f32_16x16x32_bf16 v[204:207], v[80:83], v[180:183], v[204:207]
    v_mfma_f32_16x16x32_bf16 v[224:227], v[112:115], v[180:183], v[224:227]
    v_mfma_f32_16x16x32_bf16 v[236:239], v[112:115], v[192:195], v[236:239]
    ds_read_b64_tr_b16 v[148:149], v54 offset:29184
    ds_read_b64_tr_b16 v[150:151], v54 offset:30336
    ds_read_b128 a[28:31], v15 offset:672
    v_mfma_f32_16x16x32_bf16 v[204:207], v[84:87], v[184:187], v[204:207]
    v_mfma_f32_16x16x32_bf16 v[224:227], v[116:119], v[184:187], v[224:227]
    v_mfma_f32_16x16x32_bf16 v[236:239], v[116:119], v[196:199], v[236:239]
    s_waitcnt lgkmcnt(15)
    v_cmp_lt_u32 vcc, 31, v1
    v_cndmask_b32 v120, 0, v120, vcc
    v_cndmask_b32 v121, 0, v121, vcc
    v_cndmask_b32 v122, 0, v122, vcc
    v_cndmask_b32 v123, 0, v123, vcc
    v_mfma_f32_16x16x32_bf16 v[208:211], v[56:59], v[160:163], 0
    v_mfma_f32_16x16x32_bf16 v[228:231], v[88:91], v[160:163], 0
    v_mfma_f32_16x16x32_bf16 v[244:247], v[120:123], v[168:171], 0
    s_waitcnt lgkmcnt(15)
    v_mfma_f32_16x16x32_bf16 v[208:211], v[60:63], v[164:167], v[208:211]
    v_mfma_f32_16x16x32_bf16 v[228:231], v[92:95], v[164:167], v[228:231]
    v_mfma_f32_16x16x32_bf16 v[244:247], v[124:127], v[172:175], v[244:247]
    s_waitcnt lgkmcnt(15)
    v_mfma_f32_16x16x32_bf16 v[208:211], v[64:67], v[168:171], v[208:211]
    v_mfma_f32_16x16x32_bf16 v[228:231], v[96:99], v[168:171], v[228:231]
    v_mfma_f32_16x16x32_bf16 v[244:247], v[128:131], v[176:179], v[244:247]
    s_waitcnt lgkmcnt(13)
    v_mfma_f32_16x16x32_bf16 v[208:211], v[68:71], v[172:175], v[208:211]
    v_cvt_pk_bf16_f32 v28, v204, v205
    v_cvt_pk_bf16_f32 v30, v224, v225
    v_mfma_f32_16x16x32_bf16 v[228:231], v[100:103], v[172:175], v[228:231]
    v_cvt_pk_bf16_f32 v29, v206, v207
    v_cvt_pk_bf16_f32 v31, v226, v227
    v_mfma_f32_16x16x32_bf16 v[244:247], v[132:135], v[180:183], v[244:247]
    s_nop 1
    v_permlane16_swap_b32 v28, v30
    v_permlane16_swap_b32 v29, v31
    s_waitcnt lgkmcnt(10)
    v_mfma_f32_16x16x32_bf16 v[208:211], v[72:75], v[176:179], v[208:211]
    s_nop 1
    buffer_store_dwordx4 v[28:31], v17, s[16:19], 0 offen sc1
    v_cvt_pk_bf16_f32 v40, v216, v217
    v_mfma_f32_16x16x32_bf16 v[228:231], v[104:107], v[176:179], v[228:231]
    v_cvt_pk_bf16_f32 v42, v236, v237
    v_cvt_pk_bf16_f32 v41, v218, v219
    v_mfma_f32_16x16x32_bf16 v[244:247], v[136:139], v[184:187], v[244:247]
    v_cvt_pk_bf16_f32 v43, v238, v239
    s_nop 1
    v_permlane16_swap_b32 v40, v42
    s_waitcnt lgkmcnt(7)
    v_mfma_f32_16x16x32_bf16 v[208:211], v[76:79], v[180:183], v[208:211]
    v_permlane16_swap_b32 v41, v43
    s_nop 1
    buffer_store_dwordx4 v[40:43], v20, s[16:19], 0 offen sc1
    v_mfma_f32_16x16x32_bf16 v[228:231], v[108:111], v[180:183], v[228:231]
    v_mfma_f32_16x16x32_bf16 v[244:247], v[140:143], v[188:191], v[244:247]
    s_waitcnt lgkmcnt(4)
    v_mfma_f32_16x16x32_bf16 v[208:211], v[80:83], v[184:187], v[208:211]
    v_mfma_f32_16x16x32_bf16 v[228:231], v[112:115], v[184:187], v[228:231]
    v_mfma_f32_16x16x32_bf16 v[244:247], v[144:147], v[192:195], v[244:247]
    s_waitcnt lgkmcnt(1)
    v_mfma_f32_16x16x32_bf16 v[208:211], v[84:87], v[188:191], v[208:211]
    v_mfma_f32_16x16x32_bf16 v[228:231], v[116:119], v[188:191], v[228:231]
    v_mfma_f32_16x16x32_bf16 v[244:247], v[148:151], v[196:199], v[244:247]
    s_waitcnt lgkmcnt(0)
    v_mfma_f32_16x16x32_bf16 v[212:215], v[56:59], v[164:167], 0
    v_mfma_f32_16x16x32_bf16 v[232:235], v[88:91], v[164:167], 0
    v_mfma_f32_16x16x32_bf16 v[240:243], v[120:123], a[0:3], 0
    v_mfma_f32_16x16x32_bf16 v[212:215], v[60:63], v[168:171], v[212:215]
    v_mfma_f32_16x16x32_bf16 v[232:235], v[92:95], v[168:171], v[232:235]
    v_mfma_f32_16x16x32_bf16 v[240:243], v[124:127], a[4:7], v[240:243]
    v_mfma_f32_16x16x32_bf16 v[212:215], v[64:67], v[172:175], v[212:215]
    v_mfma_f32_16x16x32_bf16 v[232:235], v[96:99], v[172:175], v[232:235]
    v_mfma_f32_16x16x32_bf16 v[240:243], v[128:131], a[8:11], v[240:243]
    v_mfma_f32_16x16x32_bf16 v[212:215], v[68:71], v[176:179], v[212:215]
    v_cvt_pk_bf16_f32 v32, v208, v209
    v_cvt_pk_bf16_f32 v34, v228, v229
    v_mfma_f32_16x16x32_bf16 v[232:235], v[100:103], v[176:179], v[232:235]
    v_cvt_pk_bf16_f32 v33, v210, v211
    v_cvt_pk_bf16_f32 v35, v230, v231
    v_mfma_f32_16x16x32_bf16 v[240:243], v[132:135], a[12:15], v[240:243]
    s_nop 1
    v_permlane16_swap_b32 v32, v34
    v_permlane16_swap_b32 v33, v35
    v_mfma_f32_16x16x32_bf16 v[212:215], v[72:75], v[180:183], v[212:215]
    s_nop 1
    buffer_store_dwordx4 v[32:35], v18, s[16:19], 0 offen sc1
    v_cvt_pk_bf16_f32 v46, v244, v245
    v_mfma_f32_16x16x32_bf16 v[232:235], v[104:107], v[180:183], v[232:235]
    v_cvt_pk_bf16_f32 v47, v246, v247
    buffer_store_dwordx2 v[46:47], v22, s[16:19], 0 offen sc1
    v_mfma_f32_16x16x32_bf16 v[240:243], v[136:139], a[16:19], v[240:243]
    v_mfma_f32_16x16x32_bf16 v[212:215], v[76:79], v[184:187], v[212:215]
    v_mfma_f32_16x16x32_bf16 v[232:235], v[108:111], v[184:187], v[232:235]
    v_mfma_f32_16x16x32_bf16 v[240:243], v[140:143], a[20:23], v[240:243]
    v_mfma_f32_16x16x32_bf16 v[212:215], v[80:83], v[188:191], v[212:215]
    v_mfma_f32_16x16x32_bf16 v[232:235], v[112:115], v[188:191], v[232:235]
    v_mfma_f32_16x16x32_bf16 v[240:243], v[144:147], a[24:27], v[240:243]
    v_mfma_f32_16x16x32_bf16 v[212:215], v[84:87], v[192:195], v[212:215]
    v_mfma_f32_16x16x32_bf16 v[232:235], v[116:119], v[192:195], v[232:235]
    v_mfma_f32_16x16x32_bf16 v[240:243], v[148:151], a[28:31], v[240:243]
    s_nop 7
    v_cvt_pk_bf16_f32 v36, v212, v213
    v_cvt_pk_bf16_f32 v38, v232, v233
    v_cvt_pk_bf16_f32 v37, v214, v215
    v_cvt_pk_bf16_f32 v39, v234, v235
    s_nop 1
    v_permlane16_swap_b32 v36, v38
    v_permlane16_swap_b32 v37, v39
    s_nop 1
    buffer_store_dwordx4 v[36:39], v19, s[16:19], 0 offen sc1
    v_cvt_pk_bf16_f32 v44, v240, v241
    v_cvt_pk_bf16_f32 v45, v242, v243
    buffer_store_dwordx2 v[44:45], v21, s[16:19], 0 offen sc1
    s_cmp_lg_u32 s32, 0
    s_cbranch_scc1 CHK_DONE
    s_mov_b32 s46, 0x40000
CHK_LOOP:
    v_cmp_ne_u32 vcc, v250, v252
    s_sub_u32 s46, s46, 1
    s_cbranch_scc1 CHK_DONE
    s_cbranch_vccz CHK_DONE
    buffer_load_dword v250, v249, s[40:43], 0 offen sc1
    s_waitcnt vmcnt(0)
    s_branch CHK_LOOP
CHK_DONE:
    s_waitcnt vmcnt(7)
    s_barrier

    v_and_b32 v6, 7, v2
    v_mul_u32_u24 v6, 576, v6
    v_lshl_add_u32 v6, v3, 4, v6
    s_mul_i32 s34, s30, 4608
    s_add_u32 s34, s34, 5242880

    buffer_load_dwordx4 v[72:75], v6, s[16:19], s34 offen offset:0 sc1
    buffer_load_dwordx4 v[76:79], v6, s[16:19], s34 offen offset:64 sc1
    buffer_load_dwordx4 v[80:83], v6, s[16:19], s34 offen offset:128 sc1
    buffer_load_dwordx4 v[84:87], v6, s[16:19], s34 offen offset:192 sc1
    buffer_load_dwordx4 v[88:91], v6, s[16:19], s34 offen offset:256 sc1
    buffer_load_dwordx4 v[92:95], v6, s[16:19], s34 offen offset:320 sc1
    buffer_load_dwordx4 v[96:99], v6, s[16:19], s34 offen offset:384 sc1
    buffer_load_dwordx4 v[100:103], v6, s[16:19], s34 offen offset:448 sc1
    buffer_load_dwordx4 v[104:107], v6, s[16:19], s34 offen offset:512 sc1
    v_add_u32 v9, 0, v254
    v_mul_u32_u24 v10, 27595, v9
    v_lshrrev_b32 v10, 26, v10
    s_add_u32 m0, s38, 0
    v_mad_i32_i24 v9, v10, s93, v9
    buffer_load_dwordx4 v9, s[84:87], 0 offen lds
    v_add_u32 v9, 4096, v254
    v_mul_u32_u24 v10, 27595, v9
    v_lshrrev_b32 v10, 26, v10
    s_add_u32 m0, s38, 4096
    v_mad_i32_i24 v9, v10, s93, v9
    buffer_load_dwordx4 v9, s[84:87], 0 offen lds
    v_add_u32 v9, 8192, v254
    v_mul_u32_u24 v10, 27595, v9
    v_lshrrev_b32 v10, 26, v10
    s_add_u32 m0, s38, 8192
    v_mad_i32_i24 v9, v10, s93, v9
    buffer_load_dwordx4 v9, s[84:87], 0 offen lds
    v_add_u32 v9, 12288, v254
    v_mul_u32_u24 v10, 27595, v9
    v_lshrrev_b32 v10, 26, v10
    s_add_u32 m0, s38, 12288
    v_mad_i32_i24 v9, v10, s93, v9
    buffer_load_dwordx4 v9, s[84:87], 0 offen lds
    v_add_u32 v9, 16384, v254
    v_mul_u32_u24 v10, 27595, v9
    v_lshrrev_b32 v10, 26, v10
    s_add_u32 m0, s38, 16384
    v_mad_i32_i24 v9, v10, s93, v9
    buffer_load_dwordx4 v9, s[84:87], 0 offen lds
    v_add_u32 v9, 20480, v254
    v_mul_u32_u24 v10, 27595, v9
    v_lshrrev_b32 v10, 26, v10
    s_add_u32 m0, s38, 20480
    v_mad_i32_i24 v9, v10, s93, v9
    buffer_load_dwordx4 v9, s[84:87], 0 offen lds
    v_add_u32 v9, 24576, v254
    v_mul_u32_u24 v10, 27595, v9
    v_lshrrev_b32 v10, 26, v10
    s_add_u32 m0, s38, 24576
    v_mad_i32_i24 v9, v10, s93, v9
    buffer_load_dwordx4 v9, s[84:87], 0 offen lds
    v_add_u32 v9, 28672, v254
    v_mul_u32_u24 v10, 27595, v9
    v_lshrrev_b32 v10, 26, v10
    s_add_u32 m0, s38, 28672
    v_mad_i32_i24 v9, v10, s93, v9
    buffer_load_dwordx4 v9, s[84:87], 0 offen lds
    v_add_u32 v9, 32768, v254
    v_mul_u32_u24 v10, 27595, v9
    v_lshrrev_b32 v10, 26, v10
    s_add_u32 m0, s38, 32768
    v_mad_i32_i24 v9, v10, s93, v9
    buffer_load_dwordx4 v9, s[84:87], 0 offen lds
    v_add_u32 v9, 36864, v254
    v_mul_u32_u24 v10, 27595, v9
    v_lshrrev_b32 v10, 26, v10
    s_add_u32 m0, s38, 36864
    v_mad_i32_i24 v9, v10, s93, v9
    buffer_load_dwordx4 v9, s[84:87], 0 offen lds
    v_add_u32 v9, 40960, v254
    v_mul_u32_u24 v10, 27595, v9
    v_lshrrev_b32 v10, 26, v10
    s_add_u32 m0, s38, 40960
    v_mad_i32_i24 v9, v10, s93, v9
    buffer_load_dwordx4 v9, s[84:87], 0 offen lds
    v_mul_u32_u24 v6, 288, v4
    v_lshl_add_u32 v6, v5, 3, v6
    v_mul_u32_u24 v7, 2432, v3
    v_add_u32 v7, v7, v6
    v_add_u32 v7, 78848, v7
    v_lshrrev_b32 v8, 1, v3
    v_mul_u32_u24 v8, 2432, v8
    v_add_u32 v6, v6, v8
    v_and_b32 v8, 1, v3
    v_mul_u32_u24 v8, 1152, v8
    v_add_u32 v6, v6, v8
    v_add_u32 v8, 117760, v6

    ds_read_b64_tr_b16 a[0:1], v7 offset:0
    ds_read_b64_tr_b16 a[2:3], v7 offset:1152
    ds_read_b64_tr_b16 a[4:5], v7 offset:9728
    ds_read_b64_tr_b16 a[6:7], v7 offset:10880
    ds_read_b64_tr_b16 a[8:9], v7 offset:19456
    ds_read_b64_tr_b16 a[10:11], v7 offset:20608
    ds_read_b64_tr_b16 a[12:13], v7 offset:29184
    ds_read_b64_tr_b16 a[14:15], v7 offset:30336
    ds_read_b64_tr_b16 a[16:17], v8 offset:0
    ds_read_b64_tr_b16 a[18:19], v7 offset:32
    ds_read_b64_tr_b16 a[20:21], v7 offset:1184
    ds_read_b64_tr_b16 a[22:23], v7 offset:9760
    ds_read_b64_tr_b16 a[24:25], v7 offset:10912
    ds_read_b64_tr_b16 a[26:27], v7 offset:19488
    ds_read_b64_tr_b16 a[28:29], v7 offset:20640
    ds_read_b64_tr_b16 a[30:31], v7 offset:29216
    ds_read_b64_tr_b16 a[32:33], v7 offset:30368
    ds_read_b64_tr_b16 a[34:35], v8 offset:32
    ds_read_b64_tr_b16 a[36:37], v7 offset:64
    ds_read_b64_tr_b16 a[38:39], v7 offset:1216
    ds_read_b64_tr_b16 a[40:41], v7 offset:9792
    ds_read_b64_tr_b16 a[42:43], v7 offset:10944
    ds_read_b64_tr_b16 a[44:45], v7 offset:19520
    ds_read_b64_tr_b16 a[46:47], v7 offset:20672
    ds_read_b64_tr_b16 a[48:49], v7 offset:29248
    ds_read_b64_tr_b16 a[50:51], v7 offset:30400
    ds_read_b64_tr_b16 a[52:53], v8 offset:64
    ds_read_b64_tr_b16 a[54:55], v7 offset:96
    ds_read_b64_tr_b16 a[56:57], v7 offset:1248
    ds_read_b64_tr_b16 a[58:59], v7 offset:9824
    ds_read_b64_tr_b16 a[60:61], v7 offset:10976
    ds_read_b64_tr_b16 a[62:63], v7 offset:19552
    ds_read_b64_tr_b16 a[64:65], v7 offset:20704
    ds_read_b64_tr_b16 a[66:67], v7 offset:29280
    ds_read_b64_tr_b16 a[68:69], v7 offset:30432
    ds_read_b64_tr_b16 a[70:71], v8 offset:96
    ds_read_b64_tr_b16 a[72:73], v7 offset:128
    ds_read_b64_tr_b16 a[74:75], v7 offset:1280
    ds_read_b64_tr_b16 a[76:77], v7 offset:9856
    ds_read_b64_tr_b16 a[78:79], v7 offset:11008
    ds_read_b64_tr_b16 a[80:81], v7 offset:19584
    ds_read_b64_tr_b16 a[82:83], v7 offset:20736
    ds_read_b64_tr_b16 a[84:85], v7 offset:29312
    ds_read_b64_tr_b16 a[86:87], v7 offset:30464
    ds_read_b64_tr_b16 a[88:89], v8 offset:128
    s_waitcnt vmcnt(20)
    s_barrier
    buffer_store_dword v253, v248, s[16:19], 0 offen sc1
    s_lshl_b32 s39, s29, 3
    s_add_u32 s39, s39, s33
    s_cmp_ge_u32 s39, 1000
    s_cbranch_scc1 K1_DRAIN

    ds_read_b64_tr_b16 a[90:91], v7 offset:160
    ds_read_b64_tr_b16 a[92:93], v7 offset:1312
    ds_read_b64_tr_b16 a[94:95], v7 offset:9888
    ds_read_b64_tr_b16 a[96:97], v7 offset:11040
    ds_read_b64_tr_b16 a[98:99], v7 offset:19616
    ds_read_b64_tr_b16 a[100:101], v7 offset:20768
    ds_read_b64_tr_b16 a[102:103], v7 offset:29344
    ds_read_b64_tr_b16 a[104:105], v7 offset:30496
    ds_read_b64_tr_b16 a[106:107], v8 offset:160
    ds_read_b64_tr_b16 a[108:109], v7 offset:192
    ds_read_b64_tr_b16 a[110:111], v7 offset:1344
    ds_read_b64_tr_b16 a[112:113], v7 offset:9920
    ds_read_b64_tr_b16 a[114:115], v7 offset:11072
    ds_read_b64_tr_b16 a[116:117], v7 offset:19648
    ds_read_b64_tr_b16 a[118:119], v7 offset:20800
    ds_read_b64_tr_b16 a[120:121], v7 offset:29376
    ds_read_b64_tr_b16 a[122:123], v7 offset:30528
    ds_read_b64_tr_b16 a[124:125], v8 offset:192
    ds_read_b64_tr_b16 a[126:127], v7 offset:224
    ds_read_b64_tr_b16 a[128:129], v7 offset:1376
    ds_read_b64_tr_b16 a[130:131], v7 offset:9952
    ds_read_b64_tr_b16 a[132:133], v7 offset:11104
    ds_read_b64_tr_b16 a[134:135], v7 offset:19680
    ds_read_b64_tr_b16 a[136:137], v7 offset:20832
    ds_read_b64_tr_b16 a[138:139], v7 offset:29408
    ds_read_b64_tr_b16 a[140:141], v7 offset:30560
    ds_read_b64_tr_b16 a[142:143], v8 offset:224
    ds_read_b64_tr_b16 a[144:145], v7 offset:256
    ds_read_b64_tr_b16 a[146:147], v7 offset:1408
    ds_read_b64_tr_b16 a[148:149], v7 offset:9984
    ds_read_b64_tr_b16 a[150:151], v7 offset:11136
    ds_read_b64_tr_b16 a[152:153], v7 offset:19712
    ds_read_b64_tr_b16 a[154:155], v7 offset:20864
    ds_read_b64_tr_b16 a[156:157], v7 offset:29440
    ds_read_b64_tr_b16 a[158:159], v7 offset:30592
    ds_read_b64_tr_b16 a[160:161], v8 offset:256
    v_mul_u32_u24 v9, 3641, v0
    v_lshrrev_b32 v9, 16, v9
    v_mul_u32_u24 v10, 18, v9
    v_sub_u32 v10, v0, v10
    s_mul_i32 s34, s30, 1008
    s_add_u32 s34, s34, s39
    s_mul_i32 s34, s34, 2592
    v_mul_u32_u24 v11, 2592, v9
    v_lshl_add_u32 v11, v10, 4, v11
    v_add_u32 v11, s34, v11
    v_mov_b32 v12, 0x80000000
    v_cmp_gt_u32 vcc, 144, v0
    v_mul_u32_u24 v13, 288, v9
    v_lshl_add_u32 v13, v10, 4, v13
    v_cndmask_b32 v11, v12, v11, vcc
    v_add_u32 v13, 46080, v13
    s_cmp_lg_u32 s32, 0
    s_cbranch_scc1 POLL_DONE
    s_mov_b32 s46, 0x40000
POLL_LOOP:
    buffer_load_dword v250, v251, s[16:19], 0 offen sc1
    s_waitcnt vmcnt(0)
    v_cmp_ne_u32 vcc, 1, v250
    s_sub_u32 s46, s46, 1
    s_cbranch_scc1 POLL_DONE
    s_cbranch_vccnz POLL_LOOP
POLL_DONE:
    s_waitcnt vmcnt(0)
    s_barrier

    buffer_load_dwordx4 v[16:19], v11, s[16:19], 0 offen offset:0 sc1
    buffer_load_dwordx4 v[20:23], v11, s[16:19], 0 offen offset:288 sc1
    buffer_load_dwordx4 v[24:27], v11, s[16:19], 0 offen offset:576 sc1
    buffer_load_dwordx4 v[28:31], v11, s[16:19], 0 offen offset:864 sc1
    buffer_load_dwordx4 v[32:35], v11, s[16:19], 0 offen offset:1152 sc1
    buffer_load_dwordx4 v[36:39], v11, s[16:19], 0 offen offset:1440 sc1
    buffer_load_dwordx4 v[40:43], v11, s[16:19], 0 offen offset:1728 sc1
    buffer_load_dwordx4 v[44:47], v11, s[16:19], 0 offen offset:2016 sc1
    buffer_load_dwordx4 v[48:51], v11, s[16:19], 0 offen offset:2304 sc1
    v_lshrrev_b32 v6, 1, v3
    v_mul_u32_u24 v6, 2432, v6
    v_and_b32 v7, 1, v3
    v_mul_u32_u24 v7, 1152, v7
    v_add_u32 v6, v6, v7
    v_mul_u32_u24 v7, 288, v4
    v_add_u32 v6, v6, v7
    v_add_u32 v6, 0, v6
    v_lshl_add_u32 v7, v5, 4, v6
    v_lshl_add_u32 v8, v5, 3, v6
    v_add_u32 v8, 256, v8
    v_add_u32 v9, 38912, v7
    v_add_u32 v10, 38912, v8

    ds_read_b64_tr_b16 a[162:163], v7 offset:0
    ds_read_b64_tr_b16 a[164:165], v7 offset:4864
    ds_read_b64_tr_b16 a[166:167], v7 offset:9728
    ds_read_b64_tr_b16 a[168:169], v7 offset:14592
    ds_read_b64_tr_b16 a[170:171], v7 offset:19456
    ds_read_b64_tr_b16 a[172:173], v7 offset:24320
    ds_read_b64_tr_b16 a[174:175], v7 offset:29184
    ds_read_b64_tr_b16 a[176:177], v7 offset:34048
    ds_read_b64_tr_b16 a[178:179], v9 offset:0
    ds_read_b64_tr_b16 a[180:181], v7 offset:8
    ds_read_b64_tr_b16 a[182:183], v7 offset:4872
    ds_read_b64_tr_b16 a[184:185], v7 offset:9736
    ds_read_b64_tr_b16 a[186:187], v7 offset:14600
    ds_read_b64_tr_b16 a[188:189], v7 offset:19464
    ds_read_b64_tr_b16 a[190:191], v7 offset:24328
    ds_read_b64_tr_b16 a[192:193], v7 offset:29192
    ds_read_b64_tr_b16 a[194:195], v7 offset:34056
    ds_read_b64_tr_b16 a[196:197], v9 offset:8
    ds_read_b64_tr_b16 a[198:199], v7 offset:64
    ds_read_b64_tr_b16 a[200:201], v7 offset:4928
    ds_read_b64_tr_b16 a[202:203], v7 offset:9792
    ds_read_b64_tr_b16 a[204:205], v7 offset:14656
    ds_read_b64_tr_b16 a[206:207], v7 offset:19520
    ds_read_b64_tr_b16 a[208:209], v7 offset:24384
    ds_read_b64_tr_b16 a[210:211], v7 offset:29248
    ds_read_b64_tr_b16 a[212:213], v7 offset:34112
    ds_read_b64_tr_b16 a[214:215], v9 offset:64
    ds_read_b64_tr_b16 a[216:217], v7 offset:72
    ds_read_b64_tr_b16 a[218:219], v7 offset:4936
    ds_read_b64_tr_b16 a[220:221], v7 offset:9800
    ds_read_b64_tr_b16 a[222:223], v7 offset:14664
    ds_read_b64_tr_b16 a[224:225], v7 offset:19528
    ds_read_b64_tr_b16 a[226:227], v7 offset:24392
    ds_read_b64_tr_b16 a[228:229], v7 offset:29256
    ds_read_b64_tr_b16 a[230:231], v7 offset:34120
    ds_read_b64_tr_b16 a[232:233], v9 offset:72
    ds_read_b64_tr_b16 a[234:235], v7 offset:128
    ds_read_b64_tr_b16 a[236:237], v7 offset:4992
    ds_read_b64_tr_b16 a[238:239], v7 offset:9856
    ds_read_b64_tr_b16 a[240:241], v7 offset:14720
    ds_read_b64_tr_b16 a[242:243], v7 offset:19584
    ds_read_b64_tr_b16 a[244:245], v7 offset:24448
    ds_read_b64_tr_b16 a[246:247], v7 offset:29312
    ds_read_b64_tr_b16 a[248:249], v7 offset:34176
    ds_read_b64_tr_b16 a[250:251], v9 offset:128
    ds_read_b64_tr_b16 v[184:185], v7 offset:136
    ds_read_b64_tr_b16 v[186:187], v7 offset:5000
    ds_read_b64_tr_b16 v[188:189], v7 offset:9864
    ds_read_b64_tr_b16 v[190:191], v7 offset:14728
    ds_read_b64_tr_b16 v[192:193], v7 offset:19592
    ds_read_b64_tr_b16 v[194:195], v7 offset:24456
    ds_read_b64_tr_b16 v[196:197], v7 offset:29320
    ds_read_b64_tr_b16 v[198:199], v7 offset:34184
    ds_read_b64_tr_b16 v[200:201], v9 offset:136
    ds_read_b64_tr_b16 v[202:203], v7 offset:192
    ds_read_b64_tr_b16 v[204:205], v7 offset:5056
    ds_read_b64_tr_b16 v[206:207], v7 offset:9920
    ds_read_b64_tr_b16 v[208:209], v7 offset:14784
    ds_read_b64_tr_b16 v[210:211], v7 offset:19648
    ds_read_b64_tr_b16 v[212:213], v7 offset:24512
    ds_read_b64_tr_b16 v[214:215], v7 offset:29376
    ds_read_b64_tr_b16 v[216:217], v7 offset:34240
    ds_read_b64_tr_b16 v[218:219], v9 offset:192
    ds_read_b64_tr_b16 v[220:221], v7 offset:200
    ds_read_b64_tr_b16 v[222:223], v7 offset:5064
    ds_read_b64_tr_b16 v[224:225], v7 offset:9928
    ds_read_b64_tr_b16 v[226:227], v7 offset:14792
    ds_read_b64_tr_b16 v[228:229], v7 offset:19656
    ds_read_b64_tr_b16 v[230:231], v7 offset:24520
    ds_read_b64_tr_b16 v[232:233], v7 offset:29384
    ds_read_b64_tr_b16 v[234:235], v7 offset:34248
    ds_read_b64_tr_b16 v[236:237], v9 offset:200
    ds_read_b64_tr_b16 v[238:239], v8 offset:0
    ds_read_b64_tr_b16 v[240:241], v8 offset:4864
    ds_read_b64_tr_b16 v[242:243], v8 offset:9728
    ds_read_b64_tr_b16 v[244:245], v8 offset:14592
    ds_read_b64_tr_b16 v[246:247], v8 offset:19456
    ds_read_b64_tr_b16 v[248:249], v8 offset:24320
    ds_read_b64_tr_b16 v[250:251], v8 offset:29184
    ds_read_b64_tr_b16 v[252:253], v8 offset:34048
    ds_read_b64_tr_b16 v[254:255], v10 offset:0
    v_mov_b32 v52, 0xc0135761
    v_mov_b32 v53, 0xbdd2d3e8
    s_mov_b32 s46, 0x00003f80
    s_mov_b32 s47, 0x3f800000
    v_lshrrev_b32 v6, 3, v2
    s_lshl_b32 s34, s32, 1
    v_add_u32 v6, s34, v6
    v_mul_u32_u24 v6, 288, v6
    v_add_u32 v6, 46080, v6
    v_lshl_add_u32 v14, v3, 4, v6
    v_lshl_add_u32 v15, v3, 3, v6
    v_mov_b32 v12, 0x4038aa3b
    s_waitcnt vmcnt(0)

    v_lshlrev_b32 v56, 16, v16
    v_and_b32 v57, 0xffff0000, v16
    v_lshlrev_b32 v58, 16, v17
    v_and_b32 v59, 0xffff0000, v17
    v_lshlrev_b32 v60, 16, v18
    v_and_b32 v61, 0xffff0000, v18
    v_lshlrev_b32 v62, 16, v19
    v_and_b32 v63, 0xffff0000, v19
    v_dot2c_f32_bf16 v56, s46, v20
    v_dot2c_f32_bf16 v57, s47, v20
    v_dot2c_f32_bf16 v58, s46, v21
    v_dot2c_f32_bf16 v59, s47, v21
    v_dot2c_f32_bf16 v60, s46, v22
    v_dot2c_f32_bf16 v61, s47, v22
    v_dot2c_f32_bf16 v62, s46, v23
    v_dot2c_f32_bf16 v63, s47, v23
    v_dot2c_f32_bf16 v56, s46, v24
    v_dot2c_f32_bf16 v57, s47, v24
    v_dot2c_f32_bf16 v58, s46, v25
    v_dot2c_f32_bf16 v59, s47, v25
    v_dot2c_f32_bf16 v60, s46, v26
    v_dot2c_f32_bf16 v61, s47, v26
    v_dot2c_f32_bf16 v62, s46, v27
    v_dot2c_f32_bf16 v63, s47, v27
    v_dot2c_f32_bf16 v56, s46, v28
    v_dot2c_f32_bf16 v57, s47, v28
    v_dot2c_f32_bf16 v58, s46, v29
    v_dot2c_f32_bf16 v59, s47, v29
    v_dot2c_f32_bf16 v60, s46, v30
    v_dot2c_f32_bf16 v61, s47, v30
    v_dot2c_f32_bf16 v62, s46, v31
    v_dot2c_f32_bf16 v63, s47, v31
    v_dot2c_f32_bf16 v56, s46, v32
    v_dot2c_f32_bf16 v57, s47, v32
    v_dot2c_f32_bf16 v58, s46, v33
    v_dot2c_f32_bf16 v59, s47, v33
    v_dot2c_f32_bf16 v60, s46, v34
    v_dot2c_f32_bf16 v61, s47, v34
    v_dot2c_f32_bf16 v62, s46, v35
    v_dot2c_f32_bf16 v63, s47, v35
    v_dot2c_f32_bf16 v56, s46, v36
    v_dot2c_f32_bf16 v57, s47, v36
    v_dot2c_f32_bf16 v58, s46, v37
    v_dot2c_f32_bf16 v59, s47, v37
    v_dot2c_f32_bf16 v60, s46, v38
    v_dot2c_f32_bf16 v61, s47, v38
    v_dot2c_f32_bf16 v62, s46, v39
    v_dot2c_f32_bf16 v63, s47, v39
    v_dot2c_f32_bf16 v56, s46, v40
    v_dot2c_f32_bf16 v57, s47, v40
    v_dot2c_f32_bf16 v58, s46, v41
    v_dot2c_f32_bf16 v59, s47, v41
    v_dot2c_f32_bf16 v60, s46, v42
    v_dot2c_f32_bf16 v61, s47, v42
    v_dot2c_f32_bf16 v62, s46, v43
    v_dot2c_f32_bf16 v63, s47, v43
    v_dot2c_f32_bf16 v56, s46, v44
    v_dot2c_f32_bf16 v57, s47, v44
    v_dot2c_f32_bf16 v58, s46, v45
    v_dot2c_f32_bf16 v59, s47, v45
    v_dot2c_f32_bf16 v60, s46, v46
    v_dot2c_f32_bf16 v61, s47, v46
    v_dot2c_f32_bf16 v62, s46, v47
    v_dot2c_f32_bf16 v63, s47, v47
    v_dot2c_f32_bf16 v56, s46, v48
    v_dot2c_f32_bf16 v57, s47, v48
    v_dot2c_f32_bf16 v58, s46, v49
    v_dot2c_f32_bf16 v59, s47, v49
    v_dot2c_f32_bf16 v60, s46, v50
    v_dot2c_f32_bf16 v61, s47, v50
    v_dot2c_f32_bf16 v62, s46, v51
    v_dot2c_f32_bf16 v63, s47, v51
    s_nop 2
    v_mul_f32 v64, v56, v56
    v_mul_f32 v65, v57, v57
    v_mul_f32 v66, v58, v58
    v_mul_f32 v67, v59, v59
    v_mul_f32 v68, v60, v60
    v_mul_f32 v69, v61, v61
    v_mul_f32 v70, v62, v62
    v_mul_f32 v71, v63, v63
    v_fma_f32 v64, v64, v53, v52
    v_fma_f32 v65, v65, v53, v52
    v_fma_f32 v66, v66, v53, v52
    v_fma_f32 v67, v67, v53, v52
    v_fma_f32 v68, v68, v53, v52
    v_fma_f32 v69, v69, v53, v52
    v_fma_f32 v70, v70, v53, v52
    v_fma_f32 v71, v71, v53, v52
    v_mul_f32 v64, v64, v56
    v_mul_f32 v65, v65, v57
    v_mul_f32 v66, v66, v58
    v_mul_f32 v67, v67, v59
    v_mul_f32 v68, v68, v60
    v_mul_f32 v69, v69, v61
    v_mul_f32 v70, v70, v62
    v_mul_f32 v71, v71, v63
    v_exp_f32 v64, v64
    v_exp_f32 v65, v65
    v_exp_f32 v66, v66
    v_exp_f32 v67, v67
    v_exp_f32 v68, v68
    v_exp_f32 v69, v69
    v_exp_f32 v70, v70
    v_exp_f32 v71, v71
    v_add_f32 v64, 1.0, v64
    v_add_f32 v65, 1.0, v65
    v_add_f32 v66, 1.0, v66
    v_add_f32 v67, 1.0, v67
    v_add_f32 v68, 1.0, v68
    v_add_f32 v69, 1.0, v69
    v_add_f32 v70, 1.0, v70
    v_add_f32 v71, 1.0, v71
    v_rcp_f32 v64, v64
    v_rcp_f32 v65, v65
    v_rcp_f32 v66, v66
    v_rcp_f32 v67, v67
    v_rcp_f32 v68, v68
    v_rcp_f32 v69, v69
    v_rcp_f32 v70, v70
    v_rcp_f32 v71, v71
    v_mul_f32 v56, v56, v64
    v_mul_f32 v57, v57, v65
    v_mul_f32 v58, v58, v66
    v_mul_f32 v59, v59, v67
    v_mul_f32 v60, v60, v68
    v_mul_f32 v61, v61, v69
    v_mul_f32 v62, v62, v70
    v_mul_f32 v63, v63, v71
    v_cvt_pk_bf16_f32 v64, v56, v57
    v_cvt_pk_bf16_f32 v65, v58, v59
    v_cvt_pk_bf16_f32 v66, v60, v61
    v_cvt_pk_bf16_f32 v67, v62, v63
    v_cmp_gt_u32 vcc, 144, v0
    s_and_saveexec_b64 s[46:47], vcc
    s_cbranch_execz K2_NOF
    ds_write_b128 v13, v[64:67]
K2_NOF:
    s_mov_b64 exec, s[46:47]
    s_waitcnt lgkmcnt(0)
    s_barrier
    ds_read_b128 v[108:111], v14 offset:0
    ds_read_b128 v[112:115], v14 offset:64
    ds_read_b128 v[116:119], v14 offset:128
    ds_read_b128 v[120:123], v14 offset:192
    ds_read_b64 v[124:125], v15 offset:256
    s_mul_i32 s34, s30, 1000
    s_add_u32 s34, s34, s39
    s_lshl_b32 s35, s32, 1
    s_add_u32 s34, s34, s35
    s_mul_i32 s34, s34, 2304
    v_mul_u32_u24 v6, 288, v2
    v_add_u32 v6, s34, v6
    v_lshl_add_u32 v7, v3, 3, v6
    v_lshl_add_u32 v6, v3, 4, v6
    s_waitcnt lgkmcnt(0)

    v_mfma_f32_16x16x16_bf16 v[72:75], a[16:17], v[124:125], v[72:75]
    v_mfma_f32_16x16x16_bf16 v[76:79], a[34:35], v[124:125], v[76:79]
    v_mfma_f32_16x16x16_bf16 v[80:83], a[52:53], v[124:125], v[80:83]
    v_mfma_f32_16x16x16_bf16 v[84:87], a[70:71], v[124:125], v[84:87]
    v_mfma_f32_16x16x16_bf16 v[88:91], a[88:89], v[124:125], v[88:91]
    v_mfma_f32_16x16x16_bf16 v[92:95], a[106:107], v[124:125], v[92:95]
    v_mfma_f32_16x16x16_bf16 v[96:99], a[124:125], v[124:125], v[96:99]
    v_mfma_f32_16x16x16_bf16 v[100:103], a[142:143], v[124:125], v[100:103]
    v_mfma_f32_16x16x16_bf16 v[104:107], a[160:161], v[124:125], v[104:107]
    v_mfma_f32_16x16x32_bf16 v[72:75], a[0:3], v[108:111], v[72:75]
    v_mfma_f32_16x16x32_bf16 v[76:79], a[18:21], v[108:111], v[76:79]
    v_mfma_f32_16x16x32_bf16 v[72:75], a[4:7], v[112:115], v[72:75]
    v_mfma_f32_16x16x32_bf16 v[76:79], a[22:25], v[112:115], v[76:79]
    v_mfma_f32_16x16x32_bf16 v[72:75], a[8:11], v[116:119], v[72:75]
    v_mfma_f32_16x16x32_bf16 v[76:79], a[26:29], v[116:119], v[76:79]
    v_mfma_f32_16x16x32_bf16 v[72:75], a[12:15], v[120:123], v[72:75]
    v_mfma_f32_16x16x32_bf16 v[76:79], a[30:33], v[120:123], v[76:79]
    v_mfma_f32_16x16x32_bf16 v[80:83], a[36:39], v[108:111], v[80:83]
    v_mfma_f32_16x16x32_bf16 v[84:87], a[54:57], v[108:111], v[84:87]
    v_mfma_f32_16x16x32_bf16 v[80:83], a[40:43], v[112:115], v[80:83]
    v_mfma_f32_16x16x32_bf16 v[84:87], a[58:61], v[112:115], v[84:87]
    v_mfma_f32_16x16x32_bf16 v[80:83], a[44:47], v[116:119], v[80:83]
    v_mfma_f32_16x16x32_bf16 v[84:87], a[62:65], v[116:119], v[84:87]
    v_mfma_f32_16x16x32_bf16 v[80:83], a[48:51], v[120:123], v[80:83]
    v_mfma_f32_16x16x32_bf16 v[84:87], a[66:69], v[120:123], v[84:87]
    v_mul_f32 v134, v12, v72
    v_mul_f32 v135, v12, v73
    v_mul_f32 v136, v12, v74
    v_mul_f32 v137, v12, v75
    v_mul_f32 v138, v12, v76
    v_mul_f32 v139, v12, v77
    v_mul_f32 v140, v12, v78
    v_mul_f32 v141, v12, v79
    v_exp_f32 v134, v134
    v_exp_f32 v135, v135
    v_exp_f32 v136, v136
    v_exp_f32 v137, v137
    v_exp_f32 v138, v138
    v_exp_f32 v139, v139
    v_exp_f32 v140, v140
    v_exp_f32 v141, v141
    v_add_f32 v134, 1.0, v134
    v_add_f32 v135, 1.0, v135
    v_add_f32 v136, 1.0, v136
    v_add_f32 v137, 1.0, v137
    v_add_f32 v138, 1.0, v138
    v_add_f32 v139, 1.0, v139
    v_add_f32 v140, 1.0, v140
    v_add_f32 v141, 1.0, v141
    v_rcp_f32 v134, v134
    v_rcp_f32 v135, v135
    v_rcp_f32 v136, v136
    v_rcp_f32 v137, v137
    v_rcp_f32 v138, v138
    v_rcp_f32 v139, v139
    v_rcp_f32 v140, v140
    v_rcp_f32 v141, v141
    v_fma_f32 v134, v134, -2.0, 1.0
    v_fma_f32 v135, v135, -2.0, 1.0
    v_fma_f32 v136, v136, -2.0, 1.0
    v_fma_f32 v137, v137, -2.0, 1.0
    v_fma_f32 v138, v138, -2.0, 1.0
    v_fma_f32 v139, v139, -2.0, 1.0
    v_fma_f32 v140, v140, -2.0, 1.0
    v_fma_f32 v141, v141, -2.0, 1.0
    v_cvt_pk_bf16_f32 v126, v134, v135
    v_cvt_pk_bf16_f32 v127, v136, v137
    v_cvt_pk_bf16_f32 v128, v138, v139
    v_cvt_pk_bf16_f32 v129, v140, v141
    v_mfma_f32_16x16x32_bf16 v[88:91], a[72:75], v[108:111], v[88:91]
    v_mfma_f32_16x16x32_bf16 v[92:95], a[90:93], v[108:111], v[92:95]
    v_mul_f32 v134, v12, v80
    v_mul_f32 v135, v12, v81
    v_mul_f32 v136, v12, v82
    v_mfma_f32_16x16x32_bf16 v[88:91], a[76:79], v[112:115], v[88:91]
    v_mul_f32 v137, v12, v83
    v_mul_f32 v138, v12, v84
    v_mul_f32 v139, v12, v85
    v_mfma_f32_16x16x32_bf16 v[92:95], a[94:97], v[112:115], v[92:95]
    v_mul_f32 v140, v12, v86
    v_mul_f32 v141, v12, v87
    v_exp_f32 v134, v134
    v_mfma_f32_16x16x32_bf16 v[88:91], a[80:83], v[116:119], v[88:91]
    v_exp_f32 v135, v135
    v_exp_f32 v136, v136
    v_exp_f32 v137, v137
    v_mfma_f32_16x16x32_bf16 v[92:95], a[98:101], v[116:119], v[92:95]
    v_exp_f32 v138, v138
    v_exp_f32 v139, v139
    v_exp_f32 v140, v140
    v_mfma_f32_16x16x32_bf16 v[88:91], a[84:87], v[120:123], v[88:91]
    v_exp_f32 v141, v141
    v_add_f32 v134, 1.0, v134
    v_add_f32 v135, 1.0, v135
    v_mfma_f32_16x16x32_bf16 v[92:95], a[102:105], v[120:123], v[92:95]
    v_add_f32 v136, 1.0, v136
    v_add_f32 v137, 1.0, v137
    v_add_f32 v138, 1.0, v138
    v_mfma_f32_16x16x32_bf16 v[144:147], a[162:165], v[126:129], 0
    v_add_f32 v139, 1.0, v139
    v_add_f32 v140, 1.0, v140
    v_add_f32 v141, 1.0, v141
    v_mfma_f32_16x16x32_bf16 v[148:151], a[180:183], v[126:129], 0
    v_rcp_f32 v134, v134
    v_rcp_f32 v135, v135
    v_rcp_f32 v136, v136
    v_mfma_f32_16x16x32_bf16 v[152:155], a[198:201], v[126:129], 0
    v_rcp_f32 v137, v137
    v_rcp_f32 v138, v138
    v_rcp_f32 v139, v139
    v_mfma_f32_16x16x32_bf16 v[156:159], a[216:219], v[126:129], 0
    v_rcp_f32 v140, v140
    v_rcp_f32 v141, v141
    v_fma_f32 v134, v134, -2.0, 1.0
    v_mfma_f32_16x16x32_bf16 v[160:163], a[234:237], v[126:129], 0
    v_fma_f32 v135, v135, -2.0, 1.0
    v_fma_f32 v136, v136, -2.0, 1.0
    v_fma_f32 v137, v137, -2.0, 1.0
    v_mfma_f32_16x16x32_bf16 v[164:167], v[184:187], v[126:129], 0
    v_fma_f32 v138, v138, -2.0, 1.0
    v_fma_f32 v139, v139, -2.0, 1.0
    v_fma_f32 v140, v140, -2.0, 1.0
    v_mfma_f32_16x16x32_bf16 v[168:171], v[202:205], v[126:129], 0
    v_fma_f32 v141, v141, -2.0, 1.0
    v_cvt_pk_bf16_f32 v130, v134, v135
    v_cvt_pk_bf16_f32 v131, v136, v137
    v_mfma_f32_16x16x32_bf16 v[172:175], v[220:223], v[126:129], 0
    v_cvt_pk_bf16_f32 v132, v138, v139
    v_cvt_pk_bf16_f32 v133, v140, v141
    v_mfma_f32_16x16x32_bf16 v[176:179], v[238:241], v[126:129], 0
    v_mfma_f32_16x16x32_bf16 v[96:99], a[108:111], v[108:111], v[96:99]
    v_mfma_f32_16x16x32_bf16 v[100:103], a[126:129], v[108:111], v[100:103]
    v_mul_f32 v134, v12, v88
    v_mul_f32 v135, v12, v89
    v_mul_f32 v136, v12, v90
    v_mfma_f32_16x16x32_bf16 v[96:99], a[112:115], v[112:115], v[96:99]
    v_mul_f32 v137, v12, v91
    v_mul_f32 v138, v12, v92
    v_mul_f32 v139, v12, v93
    v_mfma_f32_16x16x32_bf16 v[100:103], a[130:133], v[112:115], v[100:103]
    v_mul_f32 v140, v12, v94
    v_mul_f32 v141, v12, v95
    v_exp_f32 v134, v134
    v_mfma_f32_16x16x32_bf16 v[96:99], a[116:119], v[116:119], v[96:99]
    v_exp_f32 v135, v135
    v_exp_f32 v136, v136
    v_exp_f32 v137, v137
    v_mfma_f32_16x16x32_bf16 v[100:103], a[134:137], v[116:119], v[100:103]
    v_exp_f32 v138, v138
    v_exp_f32 v139, v139
    v_exp_f32 v140, v140
    v_mfma_f32_16x16x32_bf16 v[96:99], a[120:123], v[120:123], v[96:99]
    v_exp_f32 v141, v141
    v_add_f32 v134, 1.0, v134
    v_add_f32 v135, 1.0, v135
    v_mfma_f32_16x16x32_bf16 v[100:103], a[138:141], v[120:123], v[100:103]
    v_add_f32 v136, 1.0, v136
    v_add_f32 v137, 1.0, v137
    v_add_f32 v138, 1.0, v138
    v_mfma_f32_16x16x32_bf16 v[144:147], a[166:169], v[130:133], v[144:147]
    v_add_f32 v139, 1.0, v139
    v_add_f32 v140, 1.0, v140
    v_add_f32 v141, 1.0, v141
    v_mfma_f32_16x16x32_bf16 v[148:151], a[184:187], v[130:133], v[148:151]
    v_rcp_f32 v134, v134
    v_rcp_f32 v135, v135
    v_rcp_f32 v136, v136
    v_mfma_f32_16x16x32_bf16 v[152:155], a[202:205], v[130:133], v[152:155]
    v_rcp_f32 v137, v137
    v_rcp_f32 v138, v138
    v_rcp_f32 v139, v139
    v_mfma_f32_16x16x32_bf16 v[156:159], a[220:223], v[130:133], v[156:159]
    v_rcp_f32 v140, v140
    v_rcp_f32 v141, v141
    v_fma_f32 v134, v134, -2.0, 1.0
    v_mfma_f32_16x16x32_bf16 v[160:163], a[238:241], v[130:133], v[160:163]
    v_fma_f32 v135, v135, -2.0, 1.0
    v_fma_f32 v136, v136, -2.0, 1.0
    v_fma_f32 v137, v137, -2.0, 1.0
    v_mfma_f32_16x16x32_bf16 v[164:167], v[188:191], v[130:133], v[164:167]
    v_fma_f32 v138, v138, -2.0, 1.0
    v_fma_f32 v139, v139, -2.0, 1.0
    v_fma_f32 v140, v140, -2.0, 1.0
    v_mfma_f32_16x16x32_bf16 v[168:171], v[206:209], v[130:133], v[168:171]
    v_fma_f32 v141, v141, -2.0, 1.0
    v_cvt_pk_bf16_f32 v126, v134, v135
    v_cvt_pk_bf16_f32 v127, v136, v137
    v_mfma_f32_16x16x32_bf16 v[172:175], v[224:227], v[130:133], v[172:175]
    v_cvt_pk_bf16_f32 v128, v138, v139
    v_cvt_pk_bf16_f32 v129, v140, v141
    v_mfma_f32_16x16x32_bf16 v[176:179], v[242:245], v[130:133], v[176:179]
    v_mfma_f32_16x16x32_bf16 v[104:107], a[144:147], v[108:111], v[104:107]
    v_mfma_f32_16x16x32_bf16 v[104:107], a[148:151], v[112:115], v[104:107]
    v_mul_f32 v134, v12, v96
    v_mul_f32 v135, v12, v97
    v_mul_f32 v136, v12, v98
    v_mul_f32 v137, v12, v99
    v_mfma_f32_16x16x32_bf16 v[104:107], a[152:155], v[116:119], v[104:107]
    v_mul_f32 v138, v12, v100
    v_mul_f32 v139, v12, v101
    v_mul_f32 v140, v12, v102
    v_mul_f32 v141, v12, v103
    v_mfma_f32_16x16x32_bf16 v[104:107], a[156:159], v[120:123], v[104:107]
    v_exp_f32 v134, v134
    v_exp_f32 v135, v135
    v_exp_f32 v136, v136
    v_exp_f32 v137, v137
    v_mfma_f32_16x16x32_bf16 v[144:147], a[170:173], v[126:129], v[144:147]
    v_exp_f32 v138, v138
    v_exp_f32 v139, v139
    v_exp_f32 v140, v140
    v_exp_f32 v141, v141
    v_mfma_f32_16x16x32_bf16 v[148:151], a[188:191], v[126:129], v[148:151]
    v_add_f32 v134, 1.0, v134
    v_add_f32 v135, 1.0, v135
    v_add_f32 v136, 1.0, v136
    v_add_f32 v137, 1.0, v137
    v_mfma_f32_16x16x32_bf16 v[152:155], a[206:209], v[126:129], v[152:155]
    v_add_f32 v138, 1.0, v138
    v_add_f32 v139, 1.0, v139
    v_add_f32 v140, 1.0, v140
    v_add_f32 v141, 1.0, v141
    v_mfma_f32_16x16x32_bf16 v[156:159], a[224:227], v[126:129], v[156:159]
    v_rcp_f32 v134, v134
    v_rcp_f32 v135, v135
    v_rcp_f32 v136, v136
    v_rcp_f32 v137, v137
    v_mfma_f32_16x16x32_bf16 v[160:163], a[242:245], v[126:129], v[160:163]
    v_rcp_f32 v138, v138
    v_rcp_f32 v139, v139
    v_rcp_f32 v140, v140
    v_rcp_f32 v141, v141
    v_mfma_f32_16x16x32_bf16 v[164:167], v[192:195], v[126:129], v[164:167]
    v_fma_f32 v134, v134, -2.0, 1.0
    v_fma_f32 v135, v135, -2.0, 1.0
    v_fma_f32 v136, v136, -2.0, 1.0
    v_fma_f32 v137, v137, -2.0, 1.0
    v_mfma_f32_16x16x32_bf16 v[168:171], v[210:213], v[126:129], v[168:171]
    v_fma_f32 v138, v138, -2.0, 1.0
    v_fma_f32 v139, v139, -2.0, 1.0
    v_fma_f32 v140, v140, -2.0, 1.0
    v_fma_f32 v141, v141, -2.0, 1.0
    v_mfma_f32_16x16x32_bf16 v[172:175], v[228:231], v[126:129], v[172:175]
    v_cvt_pk_bf16_f32 v130, v134, v135
    v_cvt_pk_bf16_f32 v131, v136, v137
    v_cvt_pk_bf16_f32 v132, v138, v139
    v_cvt_pk_bf16_f32 v133, v140, v141
    v_mfma_f32_16x16x32_bf16 v[176:179], v[246:249], v[126:129], v[176:179]
    s_nop 7
    v_mfma_f32_16x16x32_bf16 v[144:147], a[174:177], v[130:133], v[144:147]
    v_mfma_f32_16x16x32_bf16 v[148:151], a[192:195], v[130:133], v[148:151]
    v_mul_f32 v134, v12, v104
    v_mul_f32 v135, v12, v105
    v_mul_f32 v136, v12, v106
    v_mul_f32 v137, v12, v107
    v_mfma_f32_16x16x32_bf16 v[152:155], a[210:213], v[130:133], v[152:155]
    v_exp_f32 v134, v134
    v_exp_f32 v135, v135
    v_exp_f32 v136, v136
    v_mfma_f32_16x16x32_bf16 v[156:159], a[228:231], v[130:133], v[156:159]
    v_exp_f32 v137, v137
    v_add_f32 v134, 1.0, v134
    v_add_f32 v135, 1.0, v135
    v_mfma_f32_16x16x32_bf16 v[160:163], a[246:249], v[130:133], v[160:163]
    v_add_f32 v136, 1.0, v136
    v_add_f32 v137, 1.0, v137
    v_rcp_f32 v134, v134
    v_mfma_f32_16x16x32_bf16 v[164:167], v[196:199], v[130:133], v[164:167]
    v_rcp_f32 v135, v135
    v_rcp_f32 v136, v136
    v_rcp_f32 v137, v137
    v_mfma_f32_16x16x32_bf16 v[168:171], v[214:217], v[130:133], v[168:171]
    v_fma_f32 v134, v134, -2.0, 1.0
    v_fma_f32 v135, v135, -2.0, 1.0
    v_fma_f32 v136, v136, -2.0, 1.0
    v_mfma_f32_16x16x32_bf16 v[172:175], v[232:235], v[130:133], v[172:175]
    v_fma_f32 v137, v137, -2.0, 1.0
    v_cvt_pk_bf16_f32 v126, v134, v135
    v_cvt_pk_bf16_f32 v127, v136, v137
    v_mfma_f32_16x16x32_bf16 v[176:179], v[250:253], v[130:133], v[176:179]
    s_nop 1
    v_mfma_f32_16x16x16_bf16 v[144:147], a[178:179], v[126:127], v[144:147]
    v_mfma_f32_16x16x16_bf16 v[148:151], a[196:197], v[126:127], v[148:151]
    v_mfma_f32_16x16x16_bf16 v[152:155], a[214:215], v[126:127], v[152:155]
    v_mfma_f32_16x16x16_bf16 v[156:159], a[232:233], v[126:127], v[156:159]
    v_mfma_f32_16x16x16_bf16 v[160:163], a[250:251], v[126:127], v[160:163]
    v_mfma_f32_16x16x16_bf16 v[164:167], v[200:201], v[126:127], v[164:167]
    v_mfma_f32_16x16x16_bf16 v[168:171], v[218:219], v[126:127], v[168:171]
    v_mfma_f32_16x16x16_bf16 v[172:175], v[236:237], v[126:127], v[172:175]
    v_mfma_f32_16x16x16_bf16 v[176:179], v[254:255], v[126:127], v[176:179]
    s_nop 7
    v_cvt_pk_bf16_f32 v16, v144, v145
    v_cvt_pk_bf16_f32 v17, v146, v147
    v_cvt_pk_bf16_f32 v18, v148, v149
    v_cvt_pk_bf16_f32 v19, v150, v151
    buffer_store_dwordx4 v[16:19], v6, s[88:91], 0 offen offset:0
    v_cvt_pk_bf16_f32 v20, v152, v153
    v_cvt_pk_bf16_f32 v21, v154, v155
    v_cvt_pk_bf16_f32 v22, v156, v157
    v_cvt_pk_bf16_f32 v23, v158, v159
    buffer_store_dwordx4 v[20:23], v6, s[88:91], 0 offen offset:64
    v_cvt_pk_bf16_f32 v24, v160, v161
    v_cvt_pk_bf16_f32 v25, v162, v163
    v_cvt_pk_bf16_f32 v26, v164, v165
    v_cvt_pk_bf16_f32 v27, v166, v167
    buffer_store_dwordx4 v[24:27], v6, s[88:91], 0 offen offset:128
    v_cvt_pk_bf16_f32 v28, v168, v169
    v_cvt_pk_bf16_f32 v29, v170, v171
    v_cvt_pk_bf16_f32 v30, v172, v173
    v_cvt_pk_bf16_f32 v31, v174, v175
    buffer_store_dwordx4 v[28:31], v6, s[88:91], 0 offen offset:192
    v_cvt_pk_bf16_f32 v32, v176, v177
    v_cvt_pk_bf16_f32 v33, v178, v179
    buffer_store_dwordx2 v[32:33], v7, s[88:91], 0 offen offset:256
    s_endpgm
K1_DRAIN:
    s_waitcnt vmcnt(0) lgkmcnt(0)
    s_endpgm
K1_AUX:
    s_load_dwordx2 s[40:41], s[0:1], 24
    s_load_dwordx2 s[42:43], s[0:1], 40
    v_lshrrev_b32 v6, 6, v0
    v_and_b32 v1, 63, v0

    v_readfirstlane_b32 s32, v6
    v_and_b32 v2, 15, v1
    v_lshrrev_b32 v3, 4, v1
    v_lshrrev_b32 v4, 2, v2
    v_and_b32 v5, 3, v1
    v_lshlrev_b32 v254, 4, v0
    s_mov_b32 s93, -128
    s_waitcnt lgkmcnt(0)
    s_mov_b32 s4, s40
    s_and_b32 s5, s41, 0xffff
    s_mov_b32 s6, 4608
    s_mov_b32 s7, 0x20000
    s_mov_b32 s8, s42
    s_and_b32 s9, s43, 0xffff
    s_mov_b32 s10, 41472
    s_mov_b32 s11, 0x20000
    s_mov_b32 s16, s54
    s_and_b32 s17, s55, 0xffff
    s_mov_b32 s18, 5262848
    s_mov_b32 s19, 0x20000
    s_mov_b32 s12, s52
    s_and_b32 s13, s53, 0xffff
    s_mov_b32 s14, 256
    s_mov_b32 s15, 0x20000
    s_lshl_b32 s38, s32, 10
    v_add_u32 v6, 0, v254
    v_mul_u32_u24 v7, 27595, v6
    v_lshrrev_b32 v7, 26, v7
    s_add_u32 m0, s38, 0
    v_mad_i32_i24 v6, v7, s93, v6
    buffer_load_dwordx4 v6, s[8:11], 0 offen lds
    v_add_u32 v6, 4096, v254
    v_mul_u32_u24 v7, 27595, v6
    v_lshrrev_b32 v7, 26, v7
    s_add_u32 m0, s38, 4096
    v_mad_i32_i24 v6, v7, s93, v6
    buffer_load_dwordx4 v6, s[8:11], 0 offen lds
    v_add_u32 v6, 8192, v254
    v_mul_u32_u24 v7, 27595, v6
    v_lshrrev_b32 v7, 26, v7
    s_add_u32 m0, s38, 8192
    v_mad_i32_i24 v6, v7, s93, v6
    buffer_load_dwordx4 v6, s[8:11], 0 offen lds
    v_add_u32 v6, 12288, v254
    v_mul_u32_u24 v7, 27595, v6
    v_lshrrev_b32 v7, 26, v7
    s_add_u32 m0, s38, 12288
    v_mad_i32_i24 v6, v7, s93, v6
    buffer_load_dwordx4 v6, s[8:11], 0 offen lds
    v_add_u32 v6, 16384, v254
    v_mul_u32_u24 v7, 27595, v6
    v_lshrrev_b32 v7, 26, v7
    s_add_u32 m0, s38, 16384
    v_mad_i32_i24 v6, v7, s93, v6
    buffer_load_dwordx4 v6, s[8:11], 0 offen lds
    v_add_u32 v6, 20480, v254
    v_mul_u32_u24 v7, 27595, v6
    v_lshrrev_b32 v7, 26, v7
    s_add_u32 m0, s38, 20480
    v_mad_i32_i24 v6, v7, s93, v6
    buffer_load_dwordx4 v6, s[8:11], 0 offen lds
    v_add_u32 v6, 24576, v254
    v_mul_u32_u24 v7, 27595, v6
    v_lshrrev_b32 v7, 26, v7
    s_add_u32 m0, s38, 24576
    v_mad_i32_i24 v6, v7, s93, v6
    buffer_load_dwordx4 v6, s[8:11], 0 offen lds
    v_add_u32 v6, 28672, v254
    v_mul_u32_u24 v7, 27595, v6
    v_lshrrev_b32 v7, 26, v7
    s_add_u32 m0, s38, 28672
    v_mad_i32_i24 v6, v7, s93, v6
    buffer_load_dwordx4 v6, s[8:11], 0 offen lds
    v_add_u32 v6, 32768, v254
    v_mul_u32_u24 v7, 27595, v6
    v_lshrrev_b32 v7, 26, v7
    s_add_u32 m0, s38, 32768
    v_mad_i32_i24 v6, v7, s93, v6
    buffer_load_dwordx4 v6, s[8:11], 0 offen lds
    v_add_u32 v6, 36864, v254
    v_mul_u32_u24 v7, 27595, v6
    v_lshrrev_b32 v7, 26, v7
    s_add_u32 m0, s38, 36864
    v_mad_i32_i24 v6, v7, s93, v6
    buffer_load_dwordx4 v6, s[8:11], 0 offen lds
    v_add_u32 v6, 40960, v254
    v_mul_u32_u24 v7, 27595, v6
    v_lshrrev_b32 v7, 26, v7
    s_add_u32 m0, s38, 40960
    v_mad_i32_i24 v6, v7, s93, v6
    buffer_load_dwordx4 v6, s[8:11], 0 offen lds
    v_mul_u32_u24 v6, 288, v2
    v_lshl_add_u32 v7, v3, 3, v6
    v_lshl_add_u32 v6, v3, 4, v6
    buffer_load_dwordx4 v[16:19], v6, s[4:7], 0 offen offset:0
    buffer_load_dwordx4 v[20:23], v6, s[4:7], 0 offen offset:64
    buffer_load_dwordx4 v[24:27], v6, s[4:7], 0 offen offset:128
    buffer_load_dwordx4 v[28:31], v6, s[4:7], 0 offen offset:192
    buffer_load_dwordx2 v[32:33], v7, s[4:7], 0 offen offset:256
    v_mul_u32_u24 v13, 2432, v3
    v_mul_u32_u24 v15, 288, v4
    v_lshl_add_u32 v15, v5, 3, v15
    v_add_u32 v13, v13, v15
    v_lshrrev_b32 v12, 1, v3
    v_mul_u32_u24 v12, 2432, v12
    v_add_u32 v15, v15, v12
    v_and_b32 v12, 1, v3
    v_mul_u32_u24 v12, 1152, v12
    v_add_u32 v15, v15, v12
    v_add_u32 v15, 38912, v15
    v_add_u32 v13, 0, v13
    s_lshl_b32 s34, s32, 5
    v_add_u32 v12, s34, v13
    v_add_u32 v14, s34, v15
    v_add_u32 v13, 256, v13
    v_add_u32 v15, 256, v15

    s_waitcnt vmcnt(0)
    s_barrier
    ds_read_b64_tr_b16 v[64:65], v12 offset:0
    ds_read_b64_tr_b16 v[66:67], v12 offset:1152
    ds_read_b64_tr_b16 v[68:69], v12 offset:9728
    ds_read_b64_tr_b16 v[70:71], v12 offset:10880
    ds_read_b64_tr_b16 v[72:73], v12 offset:19456
    ds_read_b64_tr_b16 v[74:75], v12 offset:20608
    ds_read_b64_tr_b16 v[76:77], v12 offset:29184
    ds_read_b64_tr_b16 v[78:79], v12 offset:30336
    ds_read_b64_tr_b16 v[80:81], v14 offset:0
    ds_read_b64_tr_b16 v[82:83], v12 offset:128
    ds_read_b64_tr_b16 v[84:85], v12 offset:1280
    ds_read_b64_tr_b16 v[86:87], v12 offset:9856
    ds_read_b64_tr_b16 v[88:89], v12 offset:11008
    ds_read_b64_tr_b16 v[90:91], v12 offset:19584
    ds_read_b64_tr_b16 v[92:93], v12 offset:20736
    ds_read_b64_tr_b16 v[94:95], v12 offset:29312
    ds_read_b64_tr_b16 v[96:97], v12 offset:30464
    ds_read_b64_tr_b16 v[98:99], v14 offset:128
    ds_read_b64_tr_b16 v[100:101], v13 offset:0
    ds_read_b64_tr_b16 v[102:103], v13 offset:1152
    ds_read_b64_tr_b16 v[104:105], v13 offset:9728
    ds_read_b64_tr_b16 v[106:107], v13 offset:10880
    ds_read_b64_tr_b16 v[108:109], v13 offset:19456
    ds_read_b64_tr_b16 v[110:111], v13 offset:20608
    ds_read_b64_tr_b16 v[112:113], v13 offset:29184
    ds_read_b64_tr_b16 v[114:115], v13 offset:30336
    ds_read_b64_tr_b16 v[116:117], v15 offset:0
    s_waitcnt lgkmcnt(0)
    v_mfma_f32_16x16x32_bf16 v[40:43], v[64:67], v[16:19], 0
    v_mfma_f32_16x16x32_bf16 v[44:47], v[82:85], v[16:19], 0
    v_mfma_f32_16x16x32_bf16 v[48:51], v[100:103], v[16:19], 0
    v_mfma_f32_16x16x32_bf16 v[40:43], v[68:71], v[20:23], v[40:43]
    v_mfma_f32_16x16x32_bf16 v[44:47], v[86:89], v[20:23], v[44:47]
    v_mfma_f32_16x16x32_bf16 v[48:51], v[104:107], v[20:23], v[48:51]
    v_mfma_f32_16x16x32_bf16 v[40:43], v[72:75], v[24:27], v[40:43]
    v_mfma_f32_16x16x32_bf16 v[44:47], v[90:93], v[24:27], v[44:47]
    v_mfma_f32_16x16x32_bf16 v[48:51], v[108:111], v[24:27], v[48:51]
    v_mfma_f32_16x16x32_bf16 v[40:43], v[76:79], v[28:31], v[40:43]
    v_mfma_f32_16x16x32_bf16 v[44:47], v[94:97], v[28:31], v[44:47]
    v_mfma_f32_16x16x32_bf16 v[48:51], v[112:115], v[28:31], v[48:51]
    s_nop 4
    v_mfma_f32_16x16x16_bf16 v[40:43], v[80:81], v[32:33], v[40:43]
    v_mfma_f32_16x16x16_bf16 v[44:47], v[98:99], v[32:33], v[44:47]
    v_mfma_f32_16x16x16_bf16 v[48:51], v[116:117], v[32:33], v[48:51]
    v_mul_u32_u24 v7, 576, v2
    v_lshl_add_u32 v7, v3, 4, v7
    v_add_u32 v7, 5242880, v7
    s_lshl_b32 s34, s32, 6
    v_add_u32 v8, s34, v7
    v_cmp_eq_u32 vcc, 0, v0
    v_mov_b32 v9, 0x80000000
    v_mov_b32 v10, 248
    v_mov_b32 v11, 1
    v_cndmask_b32 v10, v9, v10, vcc
    s_nop 7

    v_cvt_pk_bf16_f32 v60, v40, v41
    v_cvt_pk_bf16_f32 v61, v42, v43
    v_lshlrev_b32 v40, 16, v60
    v_and_b32 v41, 0xffff0000, v60
    v_lshlrev_b32 v42, 16, v61
    v_and_b32 v43, 0xffff0000, v61
    v_cvt_pk_bf16_f32 v60, v44, v45
    v_cvt_pk_bf16_f32 v61, v46, v47
    v_lshlrev_b32 v44, 16, v60
    v_and_b32 v45, 0xffff0000, v60
    v_lshlrev_b32 v46, 16, v61
    v_and_b32 v47, 0xffff0000, v61
    v_cvt_pk_bf16_f32 v60, v48, v49
    v_cvt_pk_bf16_f32 v61, v50, v51
    v_lshlrev_b32 v48, 16, v60
    v_and_b32 v49, 0xffff0000, v60
    v_lshlrev_b32 v50, 16, v61
    v_and_b32 v51, 0xffff0000, v61
    buffer_store_dwordx4 v[40:43], v8, s[16:19], 0 offen sc1
    buffer_store_dwordx4 v[44:47], v8, s[16:19], 0 offen offset:256 sc1
    buffer_store_dwordx4 v[48:51], v7, s[16:19], 0 offen offset:512 sc1
    s_waitcnt vmcnt(0)
    s_barrier
    buffer_store_dword v11, v10, s[12:15], 0 offen sc1
    s_endpgm
K1_END:
    s_endpgm
.section .rodata,"a"
.p2align 6
.amdhsa_kernel standalone__seq2seq_rnn_t_joint__speech_kernel
  .amdhsa_next_free_vgpr 512
  .amdhsa_next_free_sgpr 96
  .amdhsa_accum_offset 256
  .amdhsa_group_segment_fixed_size 0
  .amdhsa_kernarg_size 80
  .amdhsa_user_sgpr_count 2
  .amdhsa_user_sgpr_kernarg_segment_ptr 1
  .amdhsa_system_sgpr_workgroup_id_x 1
.end_amdhsa_kernel
```
